```python
import torch

def _softmax(x, axis=-1):
    return torch.softmax(x, dim=axis)
def _gelu(x):
    return torch.nn.functional.gelu(x, approximate="tanh")
def _silu(x):
    return torch.nn.functional.silu(x)
def _sigmoid(x):
    return torch.sigmoid(x)
def _layernorm(x, axis=-1, eps=1e-5):
    m = x.mean(dim=axis, keepdim=True)
    v = x.var(dim=axis, keepdim=True, unbiased=False)
    return (x - m) / torch.sqrt(v + eps)
def _scatter_add(tgt, idx, src, axis=0):
    return tgt.clone().index_add_(axis, idx, src)
def _segment_sum(src, seg, n):
    out = torch.zeros((n,) + src.shape[1:], dtype=src.dtype)
    return out.index_add_(0, seg, src)
def _pad(x, pw):
    flat = tuple(v for pair in reversed(pw) for v in pair)
    return torch.nn.functional.pad(x, flat)

kernel_name = 'concat_heads__ssm_conv_s4d__ssm_conv_s4__prompt'

def setup_inputs():

    _w = (lambda a: (lambda t: t.to(torch.bfloat16) if t.is_floating_point() else t)(torch.as_tensor(a)))
    def _A_setup():
        Bsz, L, D, N = 1, 2048, 640, 192
        return {
            "u": _w((lambda *s: torch.randn(*s, dtype=torch.bfloat16) * 0.05)(Bsz, L, D)),
            "log_A_real": _w((lambda *s: torch.randn(*s, dtype=torch.bfloat16) * 6.4)(D, N) * 0.5),
            "A_imag": _w((lambda *s: torch.randn(*s, dtype=torch.bfloat16) * 0.05)(D, N) * 3.14),
            "C_real": _w((lambda *s: torch.randn(*s, dtype=torch.bfloat16) * 0.05)(D, N) / N ** 0.5),
            "C_imag": _w((lambda *s: torch.randn(*s, dtype=torch.bfloat16) * 0.05)(D, N) / N ** 0.5),
            "log_dt": _w((lambda *s: torch.randn(*s, dtype=torch.bfloat16) * 0.05)(D) * 0.5 - 4.0),
            "D_skip": _w((lambda *s: torch.randn(*s, dtype=torch.bfloat16) * 0.05)(D)),
        }
    _A_in = _A_setup()

    def _B_setup():
        B, L, D, N = 1, 2048, 640, 192
        A_re = -(lambda _x: torch.exp(torch.as_tensor(_x)))((lambda *s: torch.randn(*s, dtype=torch.bfloat16) * 6.4)(D, N))
        A_im = torch.pi * (lambda *s: torch.randn(*s, dtype=torch.bfloat16) * 0.05)(D, N)
        B_re = (lambda *s: torch.randn(*s, dtype=torch.bfloat16) * 0.05)(D, N)
        B_im = (lambda *s: torch.randn(*s, dtype=torch.bfloat16) * 0.05)(D, N)
        C_re = (lambda *s: torch.randn(*s, dtype=torch.bfloat16) * 0.05)(D, N)
        C_im = (lambda *s: torch.randn(*s, dtype=torch.bfloat16) * 0.05)(D, N)
        log_dt = (lambda *s: torch.randn(*s, dtype=torch.bfloat16) * 0.05)(D) * 0.5 - 4.0
        Dskip = (lambda *s: torch.randn(*s, dtype=torch.bfloat16) * 0.05)(D)
        return {
            "u": _w((lambda *s: torch.randn(*s, dtype=torch.bfloat16) * 0.05)(B, L, D)),
            "A_re": _w(A_re),
            "A_im": _w(A_im),
            "B_re": _w(B_re),
            "B_im": _w(B_im),
            "C_re": _w(C_re),
            "C_im": _w(C_im),
            "log_dt": _w(log_dt),
            "Dskip": _w(Dskip),
        }
    _B_in = _B_setup()

    return {
        "A_u": _A_in["u"],
        "A_log_A_real": _A_in["log_A_real"],
        "A_A_imag": _A_in["A_imag"],
        "A_C_real": _A_in["C_real"],
        "A_C_imag": _A_in["C_imag"],
        "A_log_dt": _A_in["log_dt"],
        "A_D_skip": _A_in["D_skip"],
        "B_u": _B_in["u"],
        "B_A_re": _B_in["A_re"],
        "B_A_im": _B_in["A_im"],
        "B_B_re": _B_in["B_re"],
        "B_B_im": _B_in["B_im"],
        "B_C_re": _B_in["C_re"],
        "B_C_im": _B_in["C_im"],
        "B_log_dt": _B_in["log_dt"],
        "B_Dskip": _B_in["Dskip"],
    }

def reference(A_u, A_log_A_real, A_A_imag, A_C_real, A_C_imag, A_log_dt, A_D_skip, B_u, B_A_re, B_A_im, B_B_re, B_B_im, B_C_re, B_C_im, B_log_dt, B_Dskip):
    def _A_ref(u, log_A_real, A_imag, C_real, C_imag, log_dt, D_skip):
        L = u.shape[1]
        dt = torch.exp(log_dt)
        A = -torch.exp(log_A_real) + 1j * A_imag
        C = (C_real + 1j * C_imag) * dt[:, None]
        pos = (lambda x, dt: x.to(dt))(torch.arange(L), log_dt.dtype)
        P = torch.exp((A * dt[:, None])[:, :, None] * pos[None, None, :])
        K = 2.0 * torch.einsum("dn,dnl->dl", C, P).real
        L2 = 2 * L
        u_t = (lambda x, *d: x.permute(*d))(u, 0, 2, 1)
        Kf = (lambda x, *a, **k: torch.fft.rfft(x.float(), *a, **k))(K, L2)
        Uf = (lambda x, *a, **k: torch.fft.rfft(x.float(), *a, **k))(u_t, L2)
        y = (lambda x, *a, **k: torch.fft.irfft(x, *a, **k).to(torch.bfloat16))(Uf * Kf[None, :, :], L2)[:, :, :L]
        y = (lambda x, *d: x.permute(*d))(y, 0, 2, 1)
        return y + u * D_skip[None, None, :]

    def _B_ref(u, A_re, A_im, B_re, B_im, C_re, C_im, log_dt, Dskip):
        Bsz, L, D = u.shape
        dt = torch.exp(log_dt)[:, None]
        A = A_re + 1j * A_im
        Bc = B_re + 1j * B_im
        Cc = C_re + 1j * C_im
        logdA = dt * A
        dB = dt * Bc
        l = (lambda x, dt: x.to(dt))(torch.arange(L), A_re.dtype)
        P = torch.exp(logdA[:, :, None] * l[None, None, :])
        K = torch.einsum("dn,dnl,dn->dl", Cc, P, dB).real
        L2 = 2 * L
        Kp = _pad(K, ((0, 0), (0, L)))
        up = (lambda x, *d: x.permute(*d))(u, 0, 2, 1)
        up = _pad(up, ((0, 0), (0, 0), (0, L)))
        Kf = (lambda x, axes=(-2,-1): torch.fft.rfft2(x.float(), dim=axes))(Kp[:, None, :], axes=(-2, -1))
        Uf = (lambda x, axes=(-2,-1): torch.fft.rfft2(x.float(), dim=axes))(up[:, :, None, :], axes=(-2, -1))
        Yf = Uf * Kf[None, :, :, :]
        y = (lambda x, s, axes=(-2,-1): torch.fft.irfft2(x, s=s, dim=axes).to(torch.bfloat16))(Yf, (1, L2), axes=(-2, -1))[:, :, 0, :L]
        y = (lambda x, *d: x.permute(*d))(y, 0, 2, 1) + u * Dskip[None, None, :]
        return y

    a = _A_ref(A_u, A_log_A_real, A_A_imag, A_C_real, A_C_imag, A_log_dt, A_D_skip)
    b = _B_ref(B_u, B_A_re, B_A_im, B_B_re, B_B_im, B_C_re, B_C_im, B_log_dt, B_Dskip)
    return torch.concatenate([a, b], axis=-1)
```

```asm
; @launch grid=(256,1,1) block=(512,1,1) lds=163072
.amdgcn_target "amdgcn-amd-amdhsa--gfx950"
.text
.globl concat_heads__ssm_conv_s4d__ssm_conv_s4__prompt_kernel
.p2align 8
.type concat_heads__ssm_conv_s4d__ssm_conv_s4__prompt_kernel,@function
concat_heads__ssm_conv_s4d__ssm_conv_s4__prompt_kernel:
    s_cmp_ge_u32 s2, 256
    s_cbranch_scc1 L_end
    s_and_b32 s3, s2, 7
    s_cmp_ge_u32 s3, 4
    s_cselect_b32 s5, 56, 0
    s_load_dwordx16 s[16:31], s[0:1], s5
    s_load_dwordx8 s[32:39], s[0:1], 120
    v_lshrrev_b32 v2, 6, v0
    s_getpc_b64 s[62:63]
    s_lshr_b32 s4, s2, 3
    v_and_b32 v1, 63, v0
    v_readfirstlane_b32 s8, v2
    s_nop 0
    s_xor_b32 s12, s8, 4
    s_and_b32 s13, s8, 3
    s_cselect_b32 s8, s12, s8
    s_and_b32 s13, s3, 3
    s_mul_i32 s13, s13, 160
    s_andn2_b32 s12, s2, 7
    s_add_u32 s12, s12, s8
    s_lshl_b32 s12, s12, 6
    s_min_u32 s12, s12, (L_last - concat_heads__ssm_conv_s4d__ssm_conv_s4__prompt_kernel - 128)
    v_mov_b32 v3, s12
    global_load_dword v255, v3, s[62:63]
    s_lshl_b32 s12, s8, 1
    s_sub_u32 s11, s12, 10
    s_sub_u32 s6, s12, 9
    s_min_u32 s6, s6, 4
    s_cmp_lt_u32 s8, 5
    s_cselect_b32 s11, s8, s11
    s_cselect_b32 s6, s8, s6
    s_cselect_b32 s14, 0, 256
    s_max_u32 s15, s14, 128
    s_cmp_ge_u32 s4, 20
    s_cselect_b32 s7, 1, 0
    s_cbranch_scc1 L_rem0
    s_lshl_b32 s12, s4, 3
    s_add_u32 s13, s13, s12
    s_add_u32 s11, s11, s13
    s_add_u32 s6, s6, s13
    s_branch L_rem1
L_rem0:
    s_mul_i32 s12, s4, 5
    s_sub_u32 s12, s12, 100
    s_add_u32 s11, s11, s12
    s_add_u32 s6, s6, s12
    s_mov_b32 s61, s11
    s_mul_i32 s60, s11, 171
    s_lshr_b32 s60, s60, 9
    s_mul_i32 s12, s60, 5
    s_add_u32 s11, s11, s12
    s_mul_i32 s12, s6, 171
    s_lshr_b32 s12, s12, 9
    s_mul_i32 s12, s12, 5
    s_add_u32 s6, s6, s12
    s_add_u32 s13, s13, 5
    s_add_u32 s11, s11, s13
    s_add_u32 s6, s6, s13
L_rem1:
    s_mul_i32 s12, s11, 384
    s_add_u32 s12, s12, s14
    s_mul_i32 s13, s6, 384
    s_add_u32 s13, s13, s15
    v_lshl_add_u32 v235, v1, 1, s12
    v_lshl_add_u32 v26, v1, 1, s13
    s_lshl_b32 s12, s11, 1
    s_lshl_b32 s13, s6, 1
    v_mov_b32 v241, s12
    v_mov_b32 v27, s13
    v_mov_b64 v[2:3], 0
    v_mov_b64 v[4:5], 0
    v_mov_b64 v[6:7], 0
    v_mov_b64 v[8:9], 0
    v_mov_b64 v[10:11], 0
    v_mov_b64 v[12:13], 0
    v_mov_b64 v[14:15], 0
    v_mov_b64 v[16:17], 0
    s_cmp_lg_u32 s5, 0
    s_waitcnt lgkmcnt(0)
    s_cselect_b64 s[64:65], s[30:31], s[26:27]
    s_cselect_b64 s[68:69], s[32:33], s[28:29]
    global_load_short_d16_hi v14, v241, s[64:65]
    global_load_short_d16_hi v15, v27, s[64:65]
    global_load_short_d16_hi v2, v235, s[18:19]
    global_load_short_d16_hi v4, v235, s[20:21]
    global_load_short_d16_hi v6, v235, s[22:23]
    global_load_short_d16_hi v8, v235, s[24:25]
    global_load_short_d16_hi v3, v26, s[18:19]
    global_load_short_d16_hi v5, v26, s[20:21]
    global_load_short_d16_hi v7, v26, s[22:23]
    global_load_short_d16_hi v9, v26, s[24:25]
    global_load_short_d16_hi v16, v241, s[68:69]
    s_cbranch_scc0 L_ldE
    global_load_short_d16_hi v10, v235, s[26:27]
    global_load_short_d16_hi v12, v235, s[28:29]
    global_load_short_d16_hi v11, v26, s[26:27]
    global_load_short_d16_hi v13, v26, s[28:29]
L_ldE:
    s_setprio 3
    v_mov_b64 v[144:145], 0
    v_mov_b64 v[146:147], 0
    v_lshlrev_b32 v141, 2, v0
    v_add_u32 v141, 160000, v141
    s_mul_i32 s9, s8, 11328
    s_mov_b32 s42, 2621440
    s_mov_b32 s43, 0x20000
    s_mov_b32 s40, s16
    s_mov_b32 s41, s17
    ds_write2st64_b32 v141, v144, v144 offset0:0 offset1:4
    s_mov_b32 s46, 5242880
    s_mov_b32 s47, 0x20000
    s_mov_b32 s44, s34
    s_mov_b32 s45, s35
    s_mul_i32 s12, s4, 3
    s_add_u32 s12, s12, s8
    s_sub_u32 s12, s12, 5
    s_mov_b32 s100, 0x400000
    s_cmp_lg_u32 s7, 0
    s_cselect_b32 s60, s60, s4
    s_cselect_b32 s61, s61, s12
    s_mul_i32 s12, s3, 60
    s_add_u32 s61, s61, s12
    s_mov_b32 s55, s61
    s_mov_b32 s54, s3
    s_lshl_b32 s61, s61, 12
    s_add_u32 s61, s61, 1048576
    s_and_b32 s13, s3, 3
    s_mul_i32 s13, s13, 20
    s_add_u32 s13, s13, s60
    s_mul_i32 s3, s3, 20
    s_add_u32 s3, s3, s60
    s_lshl_b32 s13, s13, 4
    s_mov_b32 s65, s13
    s_mul_i32 s12, s8, 327680
    s_add_u32 s12, s12, s13
    v_mul_u32_u24 v234, 5120, v1
    v_add_u32 v234, s12, v234
    v_lshl_add_u32 v243, v1, 4, s61
    s_lshl_b32 s66, s54, 5
    s_mul_i32 s12, s4, 615
    s_lshr_b32 s13, s12, 10
    s_add_u32 s12, s12, 410
    s_lshr_b32 s12, s12, 10
    s_lshl_b32 s13, 1, s13
    s_lshl_b32 s12, 1, s12
    s_or_b32 s67, s12, s13
    s_sub_u32 s12, s4, 20
    s_lshl_b32 s12, 1, s12
    s_cmp_lg_u32 s7, 0
    s_cselect_b32 s67, s12, s67
    s_sub_u32 s56, s4, 20
    s_lshl_b32 s4, s7, 3
    s_add_u32 s4, s4, s8
    s_waitcnt lgkmcnt(0)
    s_barrier
    s_cmp_lg_u32 s4, 15
    s_cbranch_scc1 L_nclr
    v_mov_b64 v[148:149], -1
    v_mov_b64 v[150:151], -1
    v_subrev_u32 v152, 4096, v243
    v_subrev_u32 v153, 8192, v243
    v_subrev_u32 v154, 12288, v243
    v_subrev_u32 v155, 16384, v243
    global_store_dwordx4 v243, v[148:151], s[38:39] offset:0 sc1
    global_store_dwordx4 v243, v[148:151], s[38:39] offset:1024 sc1
    global_store_dwordx4 v243, v[148:151], s[38:39] offset:2048 sc1
    global_store_dwordx4 v243, v[148:151], s[38:39] offset:3072 sc1
    global_store_dwordx4 v152, v[148:151], s[38:39] offset:0 sc1
    global_store_dwordx4 v152, v[148:151], s[38:39] offset:1024 sc1
    global_store_dwordx4 v152, v[148:151], s[38:39] offset:2048 sc1
    global_store_dwordx4 v152, v[148:151], s[38:39] offset:3072 sc1
    global_store_dwordx4 v153, v[148:151], s[38:39] offset:0 sc1
    global_store_dwordx4 v153, v[148:151], s[38:39] offset:1024 sc1
    global_store_dwordx4 v153, v[148:151], s[38:39] offset:2048 sc1
    global_store_dwordx4 v153, v[148:151], s[38:39] offset:3072 sc1
    global_store_dwordx4 v154, v[148:151], s[38:39] offset:0 sc1
    global_store_dwordx4 v154, v[148:151], s[38:39] offset:1024 sc1
    global_store_dwordx4 v154, v[148:151], s[38:39] offset:2048 sc1
    global_store_dwordx4 v154, v[148:151], s[38:39] offset:3072 sc1
    global_store_dwordx4 v155, v[148:151], s[38:39] offset:0 sc1
    global_store_dwordx4 v155, v[148:151], s[38:39] offset:1024 sc1
    global_store_dwordx4 v155, v[148:151], s[38:39] offset:2048 sc1
    global_store_dwordx4 v155, v[148:151], s[38:39] offset:3072 sc1
    s_nop 1
L_nclr:
    s_mov_b32 m0, s9
    s_mov_b32 s48, 0x3fb8aa3b
    s_mov_b32 s49, 0xffff0000
    s_mov_b32 s57, 0x05040100
    s_mov_b32 s58, 0x07060302
    v_and_b32 v140, 15, v1
    v_lshrrev_b32 v141, 4, v1
    s_cmp_ge_u32 s4, 4
    s_cbranch_scc1 L_nou
    s_bitcmp1_b32 s3, 1
    s_cbranch_scc1 L_u2
    s_bitcmp1_b32 s3, 0
    s_cbranch_scc1 L_u1
    buffer_load_dwordx4 v[36:39], v234, s[40:43], 0 offen offset:0
    buffer_load_dwordx4 v[40:43], v234, s[40:43], 0 offen offset:1280
    buffer_load_dwordx4 v[44:47], v234, s[40:43], 0 offen offset:2560
    buffer_load_dwordx4 v[48:51], v234, s[40:43], 0 offen offset:3840
    s_branch L_nou
L_u1:
    buffer_load_dwordx4 v[40:43], v234, s[40:43], 0 offen offset:1280
    buffer_load_dwordx4 v[44:47], v234, s[40:43], 0 offen offset:2560
    buffer_load_dwordx4 v[48:51], v234, s[40:43], 0 offen offset:3840
    buffer_load_dwordx4 v[36:39], v234, s[40:43], 0 offen offset:0
    s_branch L_nou
L_u2:
    s_bitcmp1_b32 s3, 0
    s_cbranch_scc1 L_u3
    buffer_load_dwordx4 v[44:47], v234, s[40:43], 0 offen offset:2560
    buffer_load_dwordx4 v[48:51], v234, s[40:43], 0 offen offset:3840
    buffer_load_dwordx4 v[36:39], v234, s[40:43], 0 offen offset:0
    buffer_load_dwordx4 v[40:43], v234, s[40:43], 0 offen offset:1280
    s_branch L_nou
L_u3:
    buffer_load_dwordx4 v[48:51], v234, s[40:43], 0 offen offset:3840
    buffer_load_dwordx4 v[36:39], v234, s[40:43], 0 offen offset:0
    buffer_load_dwordx4 v[40:43], v234, s[40:43], 0 offen offset:1280
    buffer_load_dwordx4 v[44:47], v234, s[40:43], 0 offen offset:2560
L_nou:
    v_lshlrev_b32 v252, 2, v1
    v_add_u32 v252, 160000, v252
    v_mov_b32 v132, 0x3c00
    s_lshl_b32 s10, s8, 12
    s_add_u32 s10, s10, 90624
    v_lshl_add_u32 v148, v1, 4, s10
    s_mul_i32 s12, s8, 4576
    s_add_u32 s12, s12, 123392
    v_lshl_add_u32 v149, v1, 3, s12
    ds_write_addtid_b32 v132 offset:0
    ds_write_b128 v148, v[144:147] offset:0
    ds_write_b128 v148, v[144:147] offset:1024
    ds_write_b128 v148, v[144:147] offset:2048
    ds_write_b128 v148, v[144:147] offset:3072
    s_mov_b32 exec_hi, 0x0fffffff
    ds_write_b64 v149, v[144:145]
    s_mov_b32 exec_hi, -1
    v_mov_b32 v227, s10
    v_lshl_add_u32 v220, v140, 5, s12
    v_lshl_add_u32 v220, v141, 4, v220
    s_lshl_b32 s12, s8, 9
    s_add_u32 s12, s12, 123872
    v_lshl_add_u32 v233, v1, 3, s12
    v_lshl_add_u32 v229, v141, 4, s9
    v_mov_b32 v150, 288
    v_mad_u32_u24 v231, v140, v150, v229
    v_mov_b32 v152, 0x14131211
    v_mov_b32 v153, 0x1c1b1a19
    v_mov_b32 v154, 0x17161515
    v_mov_b32 v155, 0x1e1d1717
    v_cmp_lt_u32 vcc, 7, v140
    v_and_b32 v151, 7, v140
    v_or_b32 v151, 0x0c0c0c00, v151
    v_perm_b32 v152, v153, v152, v151
    v_perm_b32 v154, v155, v154, v151
    v_cndmask_b32 v152, v152, v154, vcc
    v_mad_u32_u24 v232, v152, v150, v229
    v_mov_b32 v152, 0x24242219
    v_mov_b32 v153, 0x25252321
    v_mov_b32 v154, 0x18182617
    v_mov_b32 v155, 0x20201f1e
    v_perm_b32 v152, v153, v152, v151
    v_perm_b32 v154, v155, v154, v151
    v_cndmask_b32 v152, v152, v154, vcc
    v_mad_u32_u24 v242, v152, v150, v229
    v_and_b32 v148, 1, v140
    v_add_u32 v149, v140, v148
    v_sub_u32 v149, 16, v149
    v_lshl_add_u32 v149, v149, 1, s10
    v_xor_b32 v151, 1, v148
    v_mul_u32_u24 v150, 1216, v151
    v_lshl_add_u32 v221, v141, 4, v149
    v_add_u32 v221, v221, v150
    v_add_u32 v222, 512, v221
    v_mul_u32_u24 v150, 832, v151
    v_lshl_add_u32 v223, v141, 3, v149
    v_add_u32 v223, v223, v150
    v_add_u32 v223, 2368, v223
    v_lshl_add_u32 v224, v1, 3, s9
    v_lshlrev_b32 v149, 4, v140
    v_and_b32 v150, 1, v141
    v_lshl_add_u32 v149, v150, 3, v149
    v_lshrrev_b32 v152, 1, v141
    v_lshl_add_u32 v149, v152, 9, v149
    s_add_u32 s12, s10, 824
    v_sub_u32 v230, s12, v149
    v_and_b32 v149, 14, v140
    v_lshlrev_b32 v153, 8, v148
    v_lshl_add_u32 v153, v150, 7, v153
    v_add_u32 v153, 46, v153
    v_mul_u32_u24 v154, 160, v148
    v_lshlrev_b32 v155, 6, v150
    v_sub_u32 v154, v154, v155
    v_add_u32 v154, 590, v154
    v_cmp_lt_u32 vcc, 31, v1
    s_add_u32 s12, s10, 2368
    s_nop 0
    v_cndmask_b32 v153, v153, v154, vcc
    v_sub_u32 v153, v153, v149
    v_add_u32 v228, s12, v153
    v_bfe_u32 v148, v1, 2, 2
    v_mul_u32_u24 v148, 11328, v148
    v_and_b32 v149, 3, v1
    v_lshl_add_u32 v150, v141, 2, v149
    v_lshl_add_u32 v148, v150, 3, v148
    s_sub_u32 s12, s8, 1
    s_cmp_ge_u32 s12, 4
    s_cselect_b32 s101, 1, 0
    s_and_b32 s12, s12, 3
    s_lshl_b32 s13, s12, 7
    s_lshl_b32 s55, s101, 9
    s_add_u32 s13, s13, s55
    v_add_u32 v225, s13, v148
    s_mul_i32 s15, s12, 10240
    v_lshrrev_b32 v148, 2, v1
    v_lshl_add_u32 v148, v148, 4, v149
    v_mul_u32_u24 v226, 2560, v148
    v_mov_b32 v253, 1
    v_mov_b32 v218, s66
    v_mov_b64 v[52:53], 0
    v_mov_b64 v[54:55], 0
    v_mov_b64 v[56:57], 0
    v_mov_b64 v[58:59], 0
    v_mov_b64 v[60:61], 0
    v_mov_b64 v[62:63], 0
    v_mov_b64 v[64:65], 0
    v_mov_b64 v[66:67], 0
    s_lshr_b32 s12, s8, 1
    s_add_u32 s12, s12, 5
    s_mul_i32 s12, s12, 11328
    s_and_b32 s13, s8, 5
    s_cselect_b32 s13, 4096, 0
    s_add_u32 s13, s13, s12
    v_lshl_add_u32 v241, v1, 4, s13
    s_mov_b32 s13, 79296
    v_lshl_add_u32 v26, v1, 4, s13
    s_lshl_b32 s14, s3, 4
    s_add_u32 s14, s14, s15
    s_mul_i32 s15, s101, 655360
    s_add_u32 s14, s14, s15
    s_cmp_lg_u32 s4, 7
    s_cbranch_scc1 L_nob
    v_lshlrev_b32 v148, 3, v141
    v_sub_u32 v148, v148, v140
    v_cvt_f32_i32 v149, v148
    v_add_f32 v150, 1.0, v149
    v_cvt_pk_f16_f32 v149, v149, v150
    s_mov_b32 s12, 0xca00ca00
    v_pk_add_f16 v152, v149, s12
    s_mov_b32 s12, 0xc900c900
    v_pk_add_f16 v153, v149, s12
    s_mov_b32 s12, 0xc800c800
    v_pk_add_f16 v154, v149, s12
    s_mov_b32 s12, 0xc600c600
    v_pk_add_f16 v155, v149, s12
    s_mov_b32 s12, 0xc400c400
    v_pk_add_f16 v156, v149, s12
    s_mov_b32 s12, 0xc000c000
    v_pk_add_f16 v157, v149, s12
    v_pk_max_f16 v152, v152, v152 neg_lo:[0,1] neg_hi:[0,1]
    v_pk_max_f16 v153, v153, v153 neg_lo:[0,1] neg_hi:[0,1]
    v_pk_max_f16 v154, v154, v154 neg_lo:[0,1] neg_hi:[0,1]
    v_pk_max_f16 v155, v155, v155 neg_lo:[0,1] neg_hi:[0,1]
    v_pk_max_f16 v156, v156, v156 neg_lo:[0,1] neg_hi:[0,1]
    v_pk_max_f16 v157, v157, v157 neg_lo:[0,1] neg_hi:[0,1]
    s_mov_b32 s12, 0x40004000
    v_pk_add_f16 v200, s12, v152 neg_lo:[0,1] neg_hi:[0,1] clamp
    v_pk_add_f16 v201, s12, v153 neg_lo:[0,1] neg_hi:[0,1] clamp
    v_pk_add_f16 v202, s12, v154 neg_lo:[0,1] neg_hi:[0,1] clamp
    v_pk_add_f16 v203, s12, v155 neg_lo:[0,1] neg_hi:[0,1] clamp
    s_mov_b32 s12, 0x42004200
    v_pk_add_f16 v204, s12, v154 neg_lo:[0,1] neg_hi:[0,1] clamp
    v_pk_add_f16 v205, s12, v155 neg_lo:[0,1] neg_hi:[0,1] clamp
    v_pk_add_f16 v206, s12, v156 neg_lo:[0,1] neg_hi:[0,1] clamp
    v_pk_add_f16 v207, s12, v157 neg_lo:[0,1] neg_hi:[0,1] clamp
    s_mov_b32 s12, 0x44004400
    v_pk_add_f16 v208, s12, v154 neg_lo:[0,1] neg_hi:[0,1] clamp
    v_pk_add_f16 v209, s12, v155 neg_lo:[0,1] neg_hi:[0,1] clamp
    v_pk_add_f16 v210, s12, v156 neg_lo:[0,1] neg_hi:[0,1] clamp
    v_pk_add_f16 v211, s12, v157 neg_lo:[0,1] neg_hi:[0,1] clamp
    s_mov_b32 s12, 0x45004500
    v_pk_add_f16 v212, s12, v154 neg_lo:[0,1] neg_hi:[0,1] clamp
    v_pk_add_f16 v213, s12, v155 neg_lo:[0,1] neg_hi:[0,1] clamp
    v_pk_add_f16 v214, s12, v156 neg_lo:[0,1] neg_hi:[0,1] clamp
    v_pk_add_f16 v215, s12, v157 neg_lo:[0,1] neg_hi:[0,1] clamp
L_nob:
    s_sub_u32 s13, s4, 13
    s_cmp_ge_u32 s13, 2
    s_cbranch_scc1 L_nrp
    s_lshl_b32 s12, s56, 6
    v_add_u32 v172, s12, v1
    v_mul_u32_u24 v173, 0x5556, v172
    v_lshrrev_b32 v173, 16, v173
    v_mul_u32_u24 v174, 3, v173
    v_sub_u32 v174, v172, v174
    v_mul_u32_u24 v173, 1280, v173
    v_lshl_add_u32 v173, v174, 7, v173
    s_and_b32 s12, s54, 3
    s_mul_i32 s12, s12, 320
    s_andn2_b32 s12, s12, 127
    s_add_u32 s13, s13, 4
    s_mul_i32 s13, s13, 327680
    s_add_u32 s12, s12, s13
    buffer_load_dword v251, v173, s[40:43], s12 offen
    s_add_u32 s12, s12, 655360
    buffer_load_dword v251, v173, s[40:43], s12 offen
L_nrp:
    s_cmp_eq_u32 s7, 0
    s_cbranch_scc1 L_w1
    s_cmp_lg_u32 s8, 7
    s_cbranch_scc1 L_w3
    v_mov_b32 v173, s67
    s_waitcnt vmcnt(0)
    s_mov_b64 exec, 1
    global_atomic_or v218, v173, s[36:37] sc1
    s_mov_b64 exec, -1
    s_branch L_w0
L_w3:
    s_cmp_lt_u32 s8, 5
    s_cbranch_scc1 L_w2
    s_waitcnt vmcnt(2)
    s_branch L_w0
L_w1:
    s_waitcnt vmcnt(4)
    s_cmp_lt_u32 s4, 4
    s_cbranch_scc1 L_w0
L_w2:
    s_waitcnt vmcnt(0)
L_w0:
    v_mul_f32 v14, s48, v14
    v_mul_f32 v15, s48, v15
    v_exp_f32 v14, v14
    v_exp_f32 v15, v15
    v_cmp_eq_u32 vcc, 0, v1
    v_cvt_pk_bf16_f32 v14, v14, v14
    v_cvt_pk_bf16_f32 v15, v15, v15
    s_cmp_lg_u32 s5, 0
    v_cndmask_b32 v236, 0, v16, vcc
    v_and_b32 v14, s49, v14
    v_and_b32 v15, s49, v15
    v_mul_f32 v34, s48, v14
    v_mul_f32 v35, s48, v15
    v_mul_f32 v180, 0.15915494, v14
    v_mul_f32 v181, 0.15915494, v15
    s_cbranch_scc1 L_prB
    v_mul_f32 v2, s48, v2
    v_mul_f32 v3, s48, v3
    v_exp_f32 v2, v2
    v_exp_f32 v3, v3
    v_max_f32_e64 v172, |v6|, |v8|
    v_max_f32_e64 v173, |v7|, |v9|
    v_cvt_pk_bf16_f32 v2, v2, v2
    v_cvt_pk_bf16_f32 v3, v3, v3
    v_mov_b32 v28, v6
    v_mov_b32 v29, v8
    v_mov_b32 v30, v7
    v_mov_b32 v31, v9
    v_and_b32 v2, s49, v2
    v_and_b32 v3, s49, v3
    v_add_f32 v237, v14, v14
    v_add_f32 v32, v15, v15
    v_mul_f32_e64 v22, -v34, v2
    v_mul_f32_e64 v24, -v35, v3
    s_branch L_prE
L_prB:
    v_mul_f32 v22, v34, v2
    v_mul_f32 v24, v35, v3
    v_mul_f32 v28, v6, v10
    v_mul_f32 v29, v6, v12
    v_mul_f32 v30, v7, v11
    v_mul_f32 v31, v7, v13
    v_max_f32 v174, 0, v22
    v_max_f32 v175, 0, v24
    v_fma_f32 v28, -v8, v12, v28
    v_fmac_f32 v29, v8, v10
    v_fma_f32 v30, -v9, v13, v30
    v_fmac_f32 v31, v9, v11
    v_mul_f32 v174, 0x44e10000, v174
    v_mul_f32 v175, 0x44e10000, v175
    v_exp_f32 v174, v174
    v_exp_f32 v175, v175
    v_max_f32_e64 v172, |v28|, |v29|
    v_max_f32_e64 v173, |v30|, |v31|
    v_mov_b32 v237, v14
    v_mov_b32 v32, v15
    v_mul_f32 v172, v172, v174
    v_mul_f32 v173, v173, v175
L_prE:
    v_mul_f32 v23, v180, v4
    v_mul_f32 v25, v181, v5
    v_rndne_f32 v176, v23
    v_rndne_f32 v177, v25
    v_sub_f32 v23, v23, v176
    v_sub_f32 v25, v25, v177
    s_setprio 3
    v_exp_f32 v16, v22
    v_max_f32_dpp v172, v172, v172 row_ror:8 row_mask:0xf bank_mask:0xf
    v_cos_f32 v4, v23
    v_max_f32_dpp v173, v173, v173 row_ror:8 row_mask:0xf bank_mask:0xf
    v_sin_f32 v5, v23
    v_max_f32_dpp v172, v172, v172 row_ror:4 row_mask:0xf bank_mask:0xf
    v_mul_f32 v4, v16, v4
    v_max_f32_dpp v173, v173, v173 row_ror:4 row_mask:0xf bank_mask:0xf
    v_mul_f32 v5, v16, v5
    v_max_f32_dpp v172, v172, v172 row_ror:2 row_mask:0xf bank_mask:0xf
    v_mul_f32 v10, v5, v5
    v_max_f32_dpp v173, v173, v173 row_ror:2 row_mask:0xf bank_mask:0xf
    v_cvt_pk_f16_f32 v18, v4, v5
    v_max_f32_dpp v172, v172, v172 row_ror:1 row_mask:0xf bank_mask:0xf
    v_mul_f32_e64 v7, v4, v5 mul:2
    v_max_f32_dpp v173, v173, v173 row_ror:1 row_mask:0xf bank_mask:0xf
    v_fma_f32 v6, v4, v4, -v10
    v_max_f32_dpp v172, v172, v172 row_bcast:15 row_mask:0xa bank_mask:0xf
    v_mul_f32 v10, v7, v7
    v_max_f32_dpp v173, v173, v173 row_bcast:15 row_mask:0xa bank_mask:0xf
    v_cvt_pk_f16_f32 v19, v6, v7
    v_max_f32_dpp v172, v172, v172 row_bcast:31 row_mask:0xc bank_mask:0xf
    v_mul_f32_e64 v5, v6, v7 mul:2
    v_max_f32_dpp v173, v173, v173 row_bcast:31 row_mask:0xc bank_mask:0xf
    v_fma_f32 v4, v6, v6, -v10
    v_readlane_b32 s52, v172, 63
    v_mul_f32 v10, v5, v5
    v_cvt_pk_f16_f32 v20, v4, v5
    v_readlane_b32 s53, v173, 63
    v_mul_f32_e64 v9, v4, v5 mul:2
    s_max_u32 s54, s52, s53
    v_fma_f32 v8, v4, v4, -v10
    s_cmp_lt_u32 s8, 5
    s_cselect_b32 s52, s54, s52
    s_cselect_b32 s53, s54, s53
    v_mul_f32 v10, v9, v9
    s_lshr_b32 s52, s52, 23
    v_cvt_pk_f16_f32 v133, v8, v9
    s_max_u32 s52, s52, 16
    v_mul_f32_e64 v5, v8, v9 mul:2
    s_min_u32 s52, s52, 254
    v_fma_f32 v4, v8, v8, -v10
    s_sub_u32 s50, 266, s52
    v_mul_f32 v10, v5, v5
    s_lshl_b32 s50, s50, 23
    v_cvt_pk_f16_f32 v134, v4, v5
    s_sub_u32 s52, s52, 12
    v_mul_f32_e64 v7, v4, v5 mul:2
    s_lshl_b32 s52, s52, 23
    v_fma_f32 v6, v4, v4, -v10
    v_mul_f32 v28, s50, v28
    v_mul_f32 v10, v7, v7
    v_mul_f32_e64 v29, s50, -v29
    v_cvt_pk_f16_f32 v136, v6, v7
    v_mul_f32_e64 v5, v6, v7 mul:2
    v_mul_f32 v237, s52, v237
    v_fma_f32 v4, v6, v6, -v10
    v_mul_f32 v235, 0x43000000, v237
    v_mul_f32 v10, v5, v5
    s_lshr_b32 s53, s53, 23
    v_cvt_pk_f16_f32 v140, v4, v5
    s_max_u32 s53, s53, 16
    v_mul_f32_e64 v7, v4, v5 mul:2
    s_min_u32 s53, s53, 254
    v_fma_f32 v6, v4, v4, -v10
    s_sub_u32 s51, 266, s53
    v_mul_f32 v10, v7, v7
    s_lshl_b32 s51, s51, 23
    v_cvt_pk_f16_f32 v148, v6, v7
    s_sub_u32 s53, s53, 12
    v_mul_f32_e64 v5, v6, v7 mul:2
    s_lshl_b32 s53, s53, 23
    v_fma_f32 v4, v6, v6, -v10
    v_mul_f32 v30, s51, v30
    v_mul_f32 v10, v5, v5
    v_mul_f32_e64 v31, s51, -v31
    v_cvt_pk_f16_f32 v21, v4, v5
    v_mul_f32 v32, s53, v32
    v_mul_f32_e64 v7, v4, v5 mul:2
    v_mul_f32 v33, 0x43000000, v32
    v_fma_f32 v6, v4, v4, -v10
    v_cvt_pk_f16_f32 v149, v28, v29
    v_mul_f32 v12, v28, v8
    v_mul_f32 v13, v29, v8
    v_fmac_f32 v12, v29, v9
    v_fma_f32 v13, -v28, v9, v13
    v_cvt_pk_f16_f32 v165, v12, v13
    v_pk_mul_f16 v238, v133, v134 op_sel:[0,0] op_sel_hi:[1,0]
    v_mul_f32 v14, v12, v6
    v_pk_mul_f16 v239, v133, v136 op_sel:[0,0] op_sel_hi:[1,0]
    v_mul_f32 v15, v13, v6
    v_pk_fma_f16 v135, v133, v134, v238 op_sel:[1,1,0] op_sel_hi:[0,1,1] neg_lo:[1,0,0]
    v_pk_fma_f16 v137, v133, v136, v239 op_sel:[1,1,0] op_sel_hi:[0,1,1] neg_lo:[1,0,0]
    ds_write_addtid_b32 v133 offset:288
    ds_write_addtid_b32 v134 offset:576
    ds_write_addtid_b32 v136 offset:1152
    ds_write_addtid_b32 v140 offset:2304
    ds_write_addtid_b32 v148 offset:4608
    ds_write_addtid_b32 v149 offset:4896
    ds_write_addtid_b32 v165 offset:9504
    ds_write_addtid_b32 v135 offset:864
    v_fmac_f32 v14, v13, v7
    v_pk_mul_f16 v238, v134, v136 op_sel:[0,0] op_sel_hi:[1,0]
    v_pk_mul_f16 v239, v135, v136 op_sel:[0,0] op_sel_hi:[1,0]
    v_fma_f32 v15, -v12, v7, v15
    v_pk_fma_f16 v138, v134, v136, v238 op_sel:[1,1,0] op_sel_hi:[0,1,1] neg_lo:[1,0,0]
    v_cvt_pk_f16_f32 v167, v14, v15
    v_pk_fma_f16 v139, v135, v136, v239 op_sel:[1,1,0] op_sel_hi:[0,1,1] neg_lo:[1,0,0]
    v_pk_mul_f16 v238, v133, v140 op_sel:[0,0] op_sel_hi:[1,0]
    v_mul_f32 v12, v14, v6
    v_pk_mul_f16 v239, v134, v140 op_sel:[0,0] op_sel_hi:[1,0]
    v_mul_f32 v13, v15, v6
    v_pk_fma_f16 v141, v133, v140, v238 op_sel:[1,1,0] op_sel_hi:[0,1,1] neg_lo:[1,0,0]
    v_pk_fma_f16 v142, v134, v140, v239 op_sel:[1,1,0] op_sel_hi:[0,1,1] neg_lo:[1,0,0]
    v_fmac_f32 v12, v15, v7
    v_pk_mul_f16 v238, v135, v140 op_sel:[0,0] op_sel_hi:[1,0]
    v_pk_mul_f16 v239, v136, v140 op_sel:[0,0] op_sel_hi:[1,0]
    v_fma_f32 v13, -v14, v7, v13
    v_pk_fma_f16 v143, v135, v140, v238 op_sel:[1,1,0] op_sel_hi:[0,1,1] neg_lo:[1,0,0]
    v_cvt_pk_f16_f32 v170, v12, v13
    v_pk_fma_f16 v144, v136, v140, v239 op_sel:[1,1,0] op_sel_hi:[0,1,1] neg_lo:[1,0,0]
    ds_write_addtid_b32 v137 offset:1440
    ds_write_addtid_b32 v138 offset:1728
    ds_write_addtid_b32 v167 offset:10080
    ds_write_addtid_b32 v139 offset:2016
    ds_write_addtid_b32 v141 offset:2592
    ds_write_addtid_b32 v142 offset:2880
    ds_write_addtid_b32 v143 offset:3168
    ds_write_addtid_b32 v170 offset:10944
    v_pk_mul_f16 v238, v137, v140 op_sel:[0,0] op_sel_hi:[1,0]
    v_mul_f32 v14, v12, v6
    v_pk_mul_f16 v239, v138, v140 op_sel:[0,0] op_sel_hi:[1,0]
    v_mul_f32 v15, v13, v6
    v_pk_fma_f16 v145, v137, v140, v238 op_sel:[1,1,0] op_sel_hi:[0,1,1] neg_lo:[1,0,0]
    v_pk_fma_f16 v146, v138, v140, v239 op_sel:[1,1,0] op_sel_hi:[0,1,1] neg_lo:[1,0,0]
    v_fmac_f32 v14, v13, v7
    v_pk_mul_f16 v238, v139, v140 op_sel:[0,0] op_sel_hi:[1,0]
    v_pk_mul_f16 v239, v149, v18 op_sel:[0,0] op_sel_hi:[1,0]
    v_fma_f32 v15, -v12, v7, v15
    v_pk_fma_f16 v147, v139, v140, v238 op_sel:[1,1,0] op_sel_hi:[0,1,1] neg_lo:[1,0,0]
    v_cvt_pk_f16_f32 v163, v14, v15
    v_pk_fma_f16 v150, v149, v18, v239 op_sel:[1,1,0] op_sel_hi:[0,1,1] neg_hi:[1,0,0]
    v_pk_mul_f16 v238, v149, v19 op_sel:[0,0] op_sel_hi:[1,0]
    v_pk_mul_f16 v239, v150, v19 op_sel:[0,0] op_sel_hi:[1,0]
    v_pk_fma_f16 v151, v149, v19, v238 op_sel:[1,1,0] op_sel_hi:[0,1,1] neg_hi:[1,0,0]
    v_pk_fma_f16 v152, v150, v19, v239 op_sel:[1,1,0] op_sel_hi:[0,1,1] neg_hi:[1,0,0]
    v_pk_mul_f16 v238, v149, v20 op_sel:[0,0] op_sel_hi:[1,0]
    v_pk_mul_f16 v239, v150, v20 op_sel:[0,0] op_sel_hi:[1,0]
    v_pk_fma_f16 v157, v149, v20, v238 op_sel:[1,1,0] op_sel_hi:[0,1,1] neg_hi:[1,0,0]
    ds_write_addtid_b32 v144 offset:3456
    ds_write_addtid_b32 v145 offset:3744
    ds_write_addtid_b32 v146 offset:4032
    ds_write_addtid_b32 v147 offset:4320
    ds_write_addtid_b32 v163 offset:8928
    ds_write_addtid_b32 v150 offset:5184
    ds_write_addtid_b32 v151 offset:5472
    ds_write_addtid_b32 v152 offset:5760
    v_pk_fma_f16 v158, v150, v20, v239 op_sel:[1,1,0] op_sel_hi:[0,1,1] neg_hi:[1,0,0]
    v_pk_mul_f16 v238, v151, v20 op_sel:[0,0] op_sel_hi:[1,0]
    v_pk_mul_f16 v239, v152, v20 op_sel:[0,0] op_sel_hi:[1,0]
    v_pk_fma_f16 v159, v151, v20, v238 op_sel:[1,1,0] op_sel_hi:[0,1,1] neg_hi:[1,0,0]
    v_pk_fma_f16 v160, v152, v20, v239 op_sel:[1,1,0] op_sel_hi:[0,1,1] neg_hi:[1,0,0]
    v_pk_mul_f16 v238, v157, v21 op_sel:[0,0] op_sel_hi:[1,0]
    v_pk_mul_f16 v239, v149, v21 op_sel:[0,0] op_sel_hi:[1,0]
    v_pk_fma_f16 v155, v157, v21, v238 op_sel:[1,1,0] op_sel_hi:[0,1,1] neg_hi:[1,0,0]
    v_pk_fma_f16 v153, v149, v21, v239 op_sel:[1,1,0] op_sel_hi:[0,1,1] neg_hi:[1,0,0]
    v_pk_mul_f16 v238, v155, v21 op_sel:[0,0] op_sel_hi:[1,0]
    v_pk_mul_f16 v239, v151, v21 op_sel:[0,0] op_sel_hi:[1,0]
    v_pk_fma_f16 v166, v155, v21, v238 op_sel:[1,1,0] op_sel_hi:[0,1,1] neg_hi:[1,0,0]
    v_pk_fma_f16 v154, v151, v21, v239 op_sel:[1,1,0] op_sel_hi:[0,1,1] neg_hi:[1,0,0]
    v_pk_mul_f16 v238, v159, v21 op_sel:[0,0] op_sel_hi:[1,0]
    v_pk_mul_f16 v239, v166, v21 op_sel:[0,0] op_sel_hi:[1,0]
    v_pk_fma_f16 v161, v159, v21, v238 op_sel:[1,1,0] op_sel_hi:[0,1,1] neg_hi:[1,0,0]
    ds_write_addtid_b32 v157 offset:7200
    ds_write_addtid_b32 v158 offset:7488
    ds_write_addtid_b32 v159 offset:7776
    ds_write_addtid_b32 v160 offset:8064
    ds_write_addtid_b32 v155 offset:6624
    ds_write_addtid_b32 v153 offset:6048
    ds_write_addtid_b32 v166 offset:9792
    ds_write_addtid_b32 v154 offset:6336
    v_pk_fma_f16 v168, v166, v21, v239 op_sel:[1,1,0] op_sel_hi:[0,1,1] neg_hi:[1,0,0]
    v_pk_mul_f16 v238, v165, v21 op_sel:[0,0] op_sel_hi:[1,0]
    v_pk_mul_f16 v239, v167, v21 op_sel:[0,0] op_sel_hi:[1,0]
    v_pk_fma_f16 v162, v165, v21, v238 op_sel:[1,1,0] op_sel_hi:[0,1,1] neg_hi:[1,0,0]
    v_pk_fma_f16 v169, v167, v21, v239 op_sel:[1,1,0] op_sel_hi:[0,1,1] neg_hi:[1,0,0]
    v_pk_mul_f16 v238, v170, v21 op_sel:[0,0] op_sel_hi:[1,0]
    v_pk_mul_f16 v239, v163, v21 op_sel:[0,0] op_sel_hi:[1,0]
    v_pk_fma_f16 v156, v170, v21, v238 op_sel:[1,1,0] op_sel_hi:[0,1,1] neg_hi:[1,0,0]
    v_pk_fma_f16 v164, v163, v21, v239 op_sel:[1,1,0] op_sel_hi:[0,1,1] neg_hi:[1,0,0]
    ds_write_addtid_b32 v161 offset:8352
    ds_write_addtid_b32 v168 offset:10368
    ds_write_addtid_b32 v162 offset:8640
    ds_write_addtid_b32 v169 offset:10656
    ds_write_addtid_b32 v156 offset:6912
    ds_write_addtid_b32 v164 offset:9216
    s_setprio 2
    s_cmp_eq_u32 s8, 7
    s_cbranch_scc1 L_r2
    ds_read_b128 v[68:71], v231 offset:0
    ds_read_b128 v[72:75], v229 offset:4608
    ds_read_b128 v[76:79], v232 offset:0
    ds_read_b128 v[80:83], v242 offset:0
    ds_read_b128 v[84:87], v231 offset:64
    ds_read_b128 v[88:91], v229 offset:4672
    ds_read_b128 v[92:95], v232 offset:64
    ds_read_b128 v[96:99], v242 offset:64
    v_exp_f32 v16, v24
    v_cos_f32 v4, v25
    v_sin_f32 v5, v25
    v_mul_f32 v4, v16, v4
    v_mul_f32 v5, v16, v5
    v_mul_f32 v10, v5, v5
    v_cvt_pk_f16_f32 v18, v4, v5
    v_mul_f32_e64 v7, v4, v5 mul:2
    v_fma_f32 v6, v4, v4, -v10
    v_mul_f32 v10, v7, v7
    v_cvt_pk_f16_f32 v19, v6, v7
    v_mul_f32_e64 v5, v6, v7 mul:2
    v_fma_f32 v4, v6, v6, -v10
    v_mul_f32 v10, v5, v5
    v_cvt_pk_f16_f32 v20, v4, v5
    v_mul_f32_e64 v9, v4, v5 mul:2
    v_fma_f32 v8, v4, v4, -v10
    s_waitcnt lgkmcnt(6)
    v_pk_mul_f16 v246, v68, v72 op_sel:[0,0] op_sel_hi:[1,0]
    v_mul_f32 v10, v9, v9
    v_cvt_pk_f16_f32 v133, v8, v9
    v_pk_mul_f16 v247, v69, v73 op_sel:[0,0] op_sel_hi:[1,0]
    v_mul_f32_e64 v5, v8, v9 mul:2
    v_fma_f32 v4, v8, v8, -v10
    v_mul_f32 v10, v5, v5
    s_waitcnt lgkmcnt(5)
    v_mfma_f32_16x16x32_f16 v[52:55], v[76:79], v[68:71], v[52:55]
    ds_read_b128 v[100:103], v231 offset:128
    ds_read_b128 v[104:107], v229 offset:4736
    ds_read_b128 v[108:111], v232 offset:128
    ds_read_b128 v[112:115], v242 offset:128
    v_cvt_pk_f16_f32 v134, v4, v5
    v_mul_f32_e64 v7, v4, v5 mul:2
    v_pk_fma_f16 v72, v68, v72, v246 op_sel:[1,1,0] op_sel_hi:[0,1,1] neg_lo:[1,0,0]
    v_fma_f32 v6, v4, v4, -v10
    v_mul_f32 v10, v7, v7
    v_pk_fma_f16 v73, v69, v73, v247 op_sel:[1,1,0] op_sel_hi:[0,1,1] neg_lo:[1,0,0]
    v_cvt_pk_f16_f32 v136, v6, v7
    v_mul_f32_e64 v5, v6, v7 mul:2
    v_pk_mul_f16 v246, v70, v74 op_sel:[0,0] op_sel_hi:[1,0]
    v_fma_f32 v4, v6, v6, -v10
    v_mul_f32 v10, v5, v5
    v_pk_mul_f16 v247, v71, v75 op_sel:[0,0] op_sel_hi:[1,0]
    v_cvt_pk_f16_f32 v140, v4, v5
    v_mul_f32_e64 v7, v4, v5 mul:2
    v_fma_f32 v6, v4, v4, -v10
    s_waitcnt lgkmcnt(8)
    v_mfma_f32_16x16x32_f16 v[60:63], v[80:83], v[68:71], v[60:63]
    ds_read_b128 v[116:119], v231 offset:192
    ds_read_b128 v[120:123], v229 offset:4800
    ds_read_b128 v[124:127], v232 offset:192
    ds_read_b128 v[128:131], v242 offset:192
    v_mul_f32 v10, v7, v7
    v_cvt_pk_f16_f32 v148, v6, v7
    v_pk_fma_f16 v74, v70, v74, v246 op_sel:[1,1,0] op_sel_hi:[0,1,1] neg_lo:[1,0,0]
    v_mul_f32_e64 v5, v6, v7 mul:2
    v_fma_f32 v4, v6, v6, -v10
    v_pk_fma_f16 v75, v71, v75, v247 op_sel:[1,1,0] op_sel_hi:[0,1,1] neg_lo:[1,0,0]
    v_mul_f32 v10, v5, v5
    v_cvt_pk_f16_f32 v21, v4, v5
    s_waitcnt lgkmcnt(10)
    v_pk_mul_f16 v246, v84, v88 op_sel:[0,0] op_sel_hi:[1,0]
    v_mul_f32_e64 v7, v4, v5 mul:2
    v_fma_f32 v6, v4, v4, -v10
    v_cvt_pk_f16_f32 v149, v30, v31
    v_mfma_f32_16x16x32_f16 v[56:59], v[76:79], v[72:75], v[56:59]
    ds_write_addtid_b32 v133 offset:288
    ds_write_addtid_b32 v134 offset:576
    ds_write_addtid_b32 v136 offset:1152
    ds_write_addtid_b32 v140 offset:2304
    v_mul_f32 v12, v30, v8
    v_mul_f32 v13, v31, v8
    v_pk_mul_f16 v247, v85, v89 op_sel:[0,0] op_sel_hi:[1,0]
    v_fmac_f32 v12, v31, v9
    v_fma_f32 v13, -v30, v9, v13
    v_pk_fma_f16 v88, v84, v88, v246 op_sel:[1,1,0] op_sel_hi:[0,1,1] neg_lo:[1,0,0]
    v_cvt_pk_f16_f32 v165, v12, v13
    v_pk_mul_f16 v238, v133, v134 op_sel:[0,0] op_sel_hi:[1,0]
    v_mfma_f32_16x16x32_f16 v[64:67], v[80:83], v[72:75], v[64:67]
    ds_write_addtid_b32 v148 offset:4608
    ds_write_addtid_b32 v149 offset:4896
    ds_write_addtid_b32 v165 offset:9504
    v_mul_f32 v14, v12, v6
    v_pk_mul_f16 v239, v133, v136 op_sel:[0,0] op_sel_hi:[1,0]
    v_pk_fma_f16 v89, v85, v89, v247 op_sel:[1,1,0] op_sel_hi:[0,1,1] neg_lo:[1,0,0]
    v_mul_f32 v15, v13, v6
    v_pk_fma_f16 v135, v133, v134, v238 op_sel:[1,1,0] op_sel_hi:[0,1,1] neg_lo:[1,0,0]
    v_pk_fma_f16 v137, v133, v136, v239 op_sel:[1,1,0] op_sel_hi:[0,1,1] neg_lo:[1,0,0]
    v_pk_mul_f16 v246, v86, v90 op_sel:[0,0] op_sel_hi:[1,0]
    v_fmac_f32 v14, v13, v7
    v_pk_mul_f16 v238, v134, v136 op_sel:[0,0] op_sel_hi:[1,0]
    s_waitcnt lgkmcnt(15)
    v_mfma_f32_16x16x32_f16 v[52:55], v[92:95], v[84:87], v[52:55]
    ds_write_addtid_b32 v135 offset:864
    ds_write_addtid_b32 v137 offset:1440
    v_pk_mul_f16 v239, v135, v136 op_sel:[0,0] op_sel_hi:[1,0]
    v_fma_f32 v15, -v12, v7, v15
    v_pk_mul_f16 v247, v87, v91 op_sel:[0,0] op_sel_hi:[1,0]
    v_pk_fma_f16 v138, v134, v136, v238 op_sel:[1,1,0] op_sel_hi:[0,1,1] neg_lo:[1,0,0]
    v_cvt_pk_f16_f32 v167, v14, v15
    v_pk_fma_f16 v90, v86, v90, v246 op_sel:[1,1,0] op_sel_hi:[0,1,1] neg_lo:[1,0,0]
    v_pk_fma_f16 v139, v135, v136, v239 op_sel:[1,1,0] op_sel_hi:[0,1,1] neg_lo:[1,0,0]
    v_pk_mul_f16 v238, v133, v140 op_sel:[0,0] op_sel_hi:[1,0]
    v_mfma_f32_16x16x32_f16 v[60:63], v[96:99], v[84:87], v[60:63]
    ds_write_addtid_b32 v138 offset:1728
    ds_write_addtid_b32 v167 offset:10080
    ds_write_addtid_b32 v139 offset:2016
    v_mul_f32 v12, v14, v6
    v_pk_mul_f16 v239, v134, v140 op_sel:[0,0] op_sel_hi:[1,0]
    v_mul_f32 v13, v15, v6
    v_pk_fma_f16 v91, v87, v91, v247 op_sel:[1,1,0] op_sel_hi:[0,1,1] neg_lo:[1,0,0]
    v_pk_fma_f16 v141, v133, v140, v238 op_sel:[1,1,0] op_sel_hi:[0,1,1] neg_lo:[1,0,0]
    v_pk_fma_f16 v142, v134, v140, v239 op_sel:[1,1,0] op_sel_hi:[0,1,1] neg_lo:[1,0,0]
    s_waitcnt lgkmcnt(15)
    v_pk_mul_f16 v246, v100, v104 op_sel:[0,0] op_sel_hi:[1,0]
    v_fmac_f32 v12, v15, v7
    v_pk_mul_f16 v238, v135, v140 op_sel:[0,0] op_sel_hi:[1,0]
    v_mfma_f32_16x16x32_f16 v[56:59], v[92:95], v[88:91], v[56:59]
    ds_write_addtid_b32 v141 offset:2592
    ds_write_addtid_b32 v142 offset:2880
    v_pk_mul_f16 v239, v136, v140 op_sel:[0,0] op_sel_hi:[1,0]
    v_fma_f32 v13, -v14, v7, v13
    v_pk_mul_f16 v247, v101, v105 op_sel:[0,0] op_sel_hi:[1,0]
    v_pk_fma_f16 v143, v135, v140, v238 op_sel:[1,1,0] op_sel_hi:[0,1,1] neg_lo:[1,0,0]
    v_cvt_pk_f16_f32 v170, v12, v13
    v_pk_fma_f16 v144, v136, v140, v239 op_sel:[1,1,0] op_sel_hi:[0,1,1] neg_lo:[1,0,0]
    v_pk_fma_f16 v104, v100, v104, v246 op_sel:[1,1,0] op_sel_hi:[0,1,1] neg_lo:[1,0,0]
    v_pk_mul_f16 v238, v137, v140 op_sel:[0,0] op_sel_hi:[1,0]
    v_mul_f32 v14, v12, v6
    v_mfma_f32_16x16x32_f16 v[64:67], v[96:99], v[88:91], v[64:67]
    ds_write_addtid_b32 v143 offset:3168
    ds_write_addtid_b32 v170 offset:10944
    ds_write_addtid_b32 v144 offset:3456
    v_pk_mul_f16 v239, v138, v140 op_sel:[0,0] op_sel_hi:[1,0]
    v_mul_f32 v15, v13, v6
    v_pk_fma_f16 v105, v101, v105, v247 op_sel:[1,1,0] op_sel_hi:[0,1,1] neg_lo:[1,0,0]
    v_pk_fma_f16 v145, v137, v140, v238 op_sel:[1,1,0] op_sel_hi:[0,1,1] neg_lo:[1,0,0]
    v_pk_fma_f16 v146, v138, v140, v239 op_sel:[1,1,0] op_sel_hi:[0,1,1] neg_lo:[1,0,0]
    v_pk_mul_f16 v246, v102, v106 op_sel:[0,0] op_sel_hi:[1,0]
    v_fmac_f32 v14, v13, v7
    v_pk_mul_f16 v238, v139, v140 op_sel:[0,0] op_sel_hi:[1,0]
    v_mfma_f32_16x16x32_f16 v[52:55], v[108:111], v[100:103], v[52:55]
    ds_write_addtid_b32 v145 offset:3744
    ds_write_addtid_b32 v146 offset:4032
    v_pk_mul_f16 v239, v149, v18 op_sel:[0,0] op_sel_hi:[1,0]
    v_fma_f32 v15, -v12, v7, v15
    v_pk_fma_f16 v147, v139, v140, v238 op_sel:[1,1,0] op_sel_hi:[0,1,1] neg_lo:[1,0,0]
    v_pk_mul_f16 v247, v103, v107 op_sel:[0,0] op_sel_hi:[1,0]
    v_cvt_pk_f16_f32 v163, v14, v15
    v_pk_fma_f16 v150, v149, v18, v239 op_sel:[1,1,0] op_sel_hi:[0,1,1] neg_hi:[1,0,0]
    v_pk_fma_f16 v106, v102, v106, v246 op_sel:[1,1,0] op_sel_hi:[0,1,1] neg_lo:[1,0,0]
    v_pk_mul_f16 v238, v149, v19 op_sel:[0,0] op_sel_hi:[1,0]
    v_pk_mul_f16 v239, v150, v19 op_sel:[0,0] op_sel_hi:[1,0]
    v_mfma_f32_16x16x32_f16 v[60:63], v[112:115], v[100:103], v[60:63]
    ds_write_addtid_b32 v147 offset:4320
    ds_write_addtid_b32 v163 offset:8928
    ds_write_addtid_b32 v150 offset:5184
    v_pk_fma_f16 v151, v149, v19, v238 op_sel:[1,1,0] op_sel_hi:[0,1,1] neg_hi:[1,0,0]
    v_pk_fma_f16 v152, v150, v19, v239 op_sel:[1,1,0] op_sel_hi:[0,1,1] neg_hi:[1,0,0]
    v_pk_fma_f16 v107, v103, v107, v247 op_sel:[1,1,0] op_sel_hi:[0,1,1] neg_lo:[1,0,0]
    v_pk_mul_f16 v238, v149, v20 op_sel:[0,0] op_sel_hi:[1,0]
    v_pk_mul_f16 v239, v150, v20 op_sel:[0,0] op_sel_hi:[1,0]
    v_pk_fma_f16 v157, v149, v20, v238 op_sel:[1,1,0] op_sel_hi:[0,1,1] neg_hi:[1,0,0]
    s_waitcnt lgkmcnt(15)
    v_pk_mul_f16 v246, v116, v120 op_sel:[0,0] op_sel_hi:[1,0]
    v_pk_fma_f16 v158, v150, v20, v239 op_sel:[1,1,0] op_sel_hi:[0,1,1] neg_hi:[1,0,0]
    v_pk_mul_f16 v238, v151, v20 op_sel:[0,0] op_sel_hi:[1,0]
    v_mfma_f32_16x16x32_f16 v[56:59], v[108:111], v[104:107], v[56:59]
    ds_write_addtid_b32 v151 offset:5472
    ds_write_addtid_b32 v152 offset:5760
    ds_write_addtid_b32 v157 offset:7200
    ds_write_addtid_b32 v158 offset:7488
    v_pk_mul_f16 v239, v152, v20 op_sel:[0,0] op_sel_hi:[1,0]
    v_pk_fma_f16 v159, v151, v20, v238 op_sel:[1,1,0] op_sel_hi:[0,1,1] neg_hi:[1,0,0]
    v_pk_mul_f16 v247, v117, v121 op_sel:[0,0] op_sel_hi:[1,0]
    v_pk_fma_f16 v160, v152, v20, v239 op_sel:[1,1,0] op_sel_hi:[0,1,1] neg_hi:[1,0,0]
    v_pk_mul_f16 v238, v157, v21 op_sel:[0,0] op_sel_hi:[1,0]
    v_pk_fma_f16 v120, v116, v120, v246 op_sel:[1,1,0] op_sel_hi:[0,1,1] neg_lo:[1,0,0]
    v_pk_mul_f16 v239, v149, v21 op_sel:[0,0] op_sel_hi:[1,0]
    v_pk_fma_f16 v155, v157, v21, v238 op_sel:[1,1,0] op_sel_hi:[0,1,1] neg_hi:[1,0,0]
    v_mfma_f32_16x16x32_f16 v[64:67], v[112:115], v[104:107], v[64:67]
    ds_write_addtid_b32 v159 offset:7776
    ds_write_addtid_b32 v160 offset:8064
    ds_write_addtid_b32 v155 offset:6624
    v_pk_fma_f16 v153, v149, v21, v239 op_sel:[1,1,0] op_sel_hi:[0,1,1] neg_hi:[1,0,0]
    v_pk_mul_f16 v238, v155, v21 op_sel:[0,0] op_sel_hi:[1,0]
    v_pk_mul_f16 v239, v151, v21 op_sel:[0,0] op_sel_hi:[1,0]
    v_pk_fma_f16 v121, v117, v121, v247 op_sel:[1,1,0] op_sel_hi:[0,1,1] neg_lo:[1,0,0]
    v_pk_fma_f16 v166, v155, v21, v238 op_sel:[1,1,0] op_sel_hi:[0,1,1] neg_hi:[1,0,0]
    v_pk_fma_f16 v154, v151, v21, v239 op_sel:[1,1,0] op_sel_hi:[0,1,1] neg_hi:[1,0,0]
    v_pk_mul_f16 v246, v118, v122 op_sel:[0,0] op_sel_hi:[1,0]
    v_pk_mul_f16 v238, v159, v21 op_sel:[0,0] op_sel_hi:[1,0]
    v_pk_mul_f16 v239, v166, v21 op_sel:[0,0] op_sel_hi:[1,0]
    v_mfma_f32_16x16x32_f16 v[52:55], v[124:127], v[116:119], v[52:55]
    ds_write_addtid_b32 v153 offset:6048
    ds_write_addtid_b32 v166 offset:9792
    ds_write_addtid_b32 v154 offset:6336
    v_pk_fma_f16 v161, v159, v21, v238 op_sel:[1,1,0] op_sel_hi:[0,1,1] neg_hi:[1,0,0]
    v_pk_fma_f16 v168, v166, v21, v239 op_sel:[1,1,0] op_sel_hi:[0,1,1] neg_hi:[1,0,0]
    v_pk_mul_f16 v247, v119, v123 op_sel:[0,0] op_sel_hi:[1,0]
    v_pk_mul_f16 v238, v165, v21 op_sel:[0,0] op_sel_hi:[1,0]
    v_pk_mul_f16 v239, v167, v21 op_sel:[0,0] op_sel_hi:[1,0]
    v_pk_fma_f16 v122, v118, v122, v246 op_sel:[1,1,0] op_sel_hi:[0,1,1] neg_lo:[1,0,0]
    v_pk_fma_f16 v162, v165, v21, v238 op_sel:[1,1,0] op_sel_hi:[0,1,1] neg_hi:[1,0,0]
    v_pk_fma_f16 v169, v167, v21, v239 op_sel:[1,1,0] op_sel_hi:[0,1,1] neg_hi:[1,0,0]
    v_pk_mul_f16 v238, v170, v21 op_sel:[0,0] op_sel_hi:[1,0]
    v_mfma_f32_16x16x32_f16 v[60:63], v[128:131], v[116:119], v[60:63]
    ds_write_addtid_b32 v161 offset:8352
    ds_write_addtid_b32 v168 offset:10368
    ds_write_addtid_b32 v162 offset:8640
    ds_write_addtid_b32 v169 offset:10656
    v_pk_mul_f16 v239, v163, v21 op_sel:[0,0] op_sel_hi:[1,0]
    v_pk_fma_f16 v156, v170, v21, v238 op_sel:[1,1,0] op_sel_hi:[0,1,1] neg_hi:[1,0,0]
    v_pk_fma_f16 v123, v119, v123, v247 op_sel:[1,1,0] op_sel_hi:[0,1,1] neg_lo:[1,0,0]
    v_pk_fma_f16 v164, v163, v21, v239 op_sel:[1,1,0] op_sel_hi:[0,1,1] neg_hi:[1,0,0]
    s_nop 0
    v_mfma_f32_16x16x32_f16 v[56:59], v[124:127], v[120:123], v[56:59]
    ds_write_addtid_b32 v156 offset:6912
    ds_write_addtid_b32 v164 offset:9216
    v_mfma_f32_16x16x32_f16 v[64:67], v[128:131], v[120:123], v[64:67]
    s_cmp_lt_u32 s8, 5
    s_cbranch_scc1 L_r2
    v_mul_f32 v200, v237, v52
    v_mul_f32 v201, v237, v53
    v_mul_f32 v202, v237, v54
    v_mul_f32 v203, v237, v55
    v_mul_f32 v208, v237, v60
    v_mul_f32 v209, v235, v61
    v_mul_f32 v210, v235, v62
    v_mul_f32 v204, v237, v56
    v_mul_f32 v205, v237, v57
    v_mul_f32 v206, v237, v58
    v_mul_f32 v207, v237, v59
    v_mul_f32 v212, v237, v64
    v_mul_f32 v213, v235, v65
    v_mul_f32 v214, v235, v66
    v_mov_b32 v52, 0
    v_mov_b32 v53, 0
    v_mov_b32 v54, 0
    v_mov_b32 v55, 0
    v_mov_b32 v56, 0
    v_mov_b32 v57, 0
    v_mov_b32 v58, 0
    v_mov_b32 v59, 0
    v_mov_b32 v60, 0
    v_mov_b32 v61, 0
    v_mov_b32 v62, 0
    v_mov_b32 v63, 0
    v_mov_b32 v64, 0
    v_mov_b32 v65, 0
    v_mov_b32 v66, 0
    v_mov_b32 v67, 0
L_r2:
    s_setprio 1
    ds_read_b128 v[68:71], v231 offset:0
    ds_read_b128 v[72:75], v229 offset:4608
    ds_read_b128 v[76:79], v232 offset:0
    ds_read_b128 v[80:83], v242 offset:0
    ds_read_b128 v[84:87], v231 offset:64
    ds_read_b128 v[88:91], v229 offset:4672
    ds_read_b128 v[92:95], v232 offset:64
    ds_read_b128 v[96:99], v242 offset:64
    ds_read_b128 v[100:103], v231 offset:128
    ds_read_b128 v[104:107], v229 offset:4736
    ds_read_b128 v[108:111], v232 offset:128
    ds_read_b128 v[112:115], v242 offset:128
    ds_read_b128 v[116:119], v231 offset:192
    ds_read_b128 v[120:123], v229 offset:4800
    ds_read_b128 v[124:127], v232 offset:192
    ds_read_b128 v[128:131], v242 offset:192
    s_cmp_ge_u32 s4, 4
    s_cbranch_scc1 L_utA
    s_waitcnt vmcnt(0)
    v_perm_b32 v172, v40, v36, s57
    v_perm_b32 v173, v48, v44, s57
    v_perm_b32 v174, v40, v36, s58
    v_perm_b32 v175, v48, v44, s58
    v_perm_b32 v176, v41, v37, s57
    v_perm_b32 v177, v49, v45, s57
    v_perm_b32 v178, v41, v37, s58
    v_perm_b32 v179, v49, v45, s58
    v_perm_b32 v180, v42, v38, s57
    v_perm_b32 v181, v50, v46, s57
    v_perm_b32 v182, v42, v38, s58
    v_perm_b32 v183, v50, v46, s58
    v_perm_b32 v184, v43, v39, s57
    v_perm_b32 v185, v51, v47, s57
    v_perm_b32 v186, v43, v39, s58
    v_perm_b32 v187, v51, v47, s58
    ds_write_b64 v233, v[172:173] offset:0
    ds_write_b64 v233, v[174:175] offset:4576
    ds_write_b64 v233, v[176:177] offset:9152
    ds_write_b64 v233, v[178:179] offset:13728
    ds_write_b64 v233, v[180:181] offset:18304
    ds_write_b64 v233, v[182:183] offset:22880
    ds_write_b64 v233, v[184:185] offset:27456
    ds_write_b64 v233, v[186:187] offset:32032
    ds_add_u32 v252, v253 offset:2048
L_utA:
    s_waitcnt lgkmcnt(14)
    v_pk_mul_f16 v246, v68, v72 op_sel:[0,0] op_sel_hi:[1,0]
    v_pk_mul_f16 v247, v69, v73 op_sel:[0,0] op_sel_hi:[1,0]
    s_waitcnt lgkmcnt(13)
    v_mfma_f32_16x16x32_f16 v[52:55], v[76:79], v[68:71], v[52:55]
    v_pk_fma_f16 v72, v68, v72, v246 op_sel:[1,1,0] op_sel_hi:[0,1,1] neg_lo:[1,0,0]
    v_pk_fma_f16 v73, v69, v73, v247 op_sel:[1,1,0] op_sel_hi:[0,1,1] neg_lo:[1,0,0]
    v_pk_mul_f16 v246, v70, v74 op_sel:[0,0] op_sel_hi:[1,0]
    v_pk_mul_f16 v247, v71, v75 op_sel:[0,0] op_sel_hi:[1,0]
    s_waitcnt lgkmcnt(12)
    v_mfma_f32_16x16x32_f16 v[60:63], v[80:83], v[68:71], v[60:63]
    v_pk_fma_f16 v74, v70, v74, v246 op_sel:[1,1,0] op_sel_hi:[0,1,1] neg_lo:[1,0,0]
    v_pk_fma_f16 v75, v71, v75, v247 op_sel:[1,1,0] op_sel_hi:[0,1,1] neg_lo:[1,0,0]
    s_waitcnt lgkmcnt(10)
    v_pk_mul_f16 v246, v84, v88 op_sel:[0,0] op_sel_hi:[1,0]
    v_mfma_f32_16x16x32_f16 v[56:59], v[76:79], v[72:75], v[56:59]
    v_pk_mul_f16 v247, v85, v89 op_sel:[0,0] op_sel_hi:[1,0]
    v_pk_fma_f16 v88, v84, v88, v246 op_sel:[1,1,0] op_sel_hi:[0,1,1] neg_lo:[1,0,0]
    v_mfma_f32_16x16x32_f16 v[64:67], v[80:83], v[72:75], v[64:67]
    v_pk_fma_f16 v89, v85, v89, v247 op_sel:[1,1,0] op_sel_hi:[0,1,1] neg_lo:[1,0,0]
    v_pk_mul_f16 v246, v86, v90 op_sel:[0,0] op_sel_hi:[1,0]
    s_waitcnt lgkmcnt(9)
    v_mfma_f32_16x16x32_f16 v[52:55], v[92:95], v[84:87], v[52:55]
    v_pk_mul_f16 v247, v87, v91 op_sel:[0,0] op_sel_hi:[1,0]
    v_pk_fma_f16 v90, v86, v90, v246 op_sel:[1,1,0] op_sel_hi:[0,1,1] neg_lo:[1,0,0]
    s_waitcnt lgkmcnt(8)
    v_mfma_f32_16x16x32_f16 v[60:63], v[96:99], v[84:87], v[60:63]
    v_pk_fma_f16 v91, v87, v91, v247 op_sel:[1,1,0] op_sel_hi:[0,1,1] neg_lo:[1,0,0]
    s_waitcnt lgkmcnt(6)
    v_pk_mul_f16 v246, v100, v104 op_sel:[0,0] op_sel_hi:[1,0]
    v_mfma_f32_16x16x32_f16 v[56:59], v[92:95], v[88:91], v[56:59]
    v_pk_mul_f16 v247, v101, v105 op_sel:[0,0] op_sel_hi:[1,0]
    v_pk_fma_f16 v104, v100, v104, v246 op_sel:[1,1,0] op_sel_hi:[0,1,1] neg_lo:[1,0,0]
    ds_read_b32 v255, v252 offset:2560
    v_mfma_f32_16x16x32_f16 v[64:67], v[96:99], v[88:91], v[64:67]
    v_pk_fma_f16 v105, v101, v105, v247 op_sel:[1,1,0] op_sel_hi:[0,1,1] neg_lo:[1,0,0]
    v_pk_mul_f16 v246, v102, v106 op_sel:[0,0] op_sel_hi:[1,0]
    s_waitcnt lgkmcnt(6)
    v_mfma_f32_16x16x32_f16 v[52:55], v[108:111], v[100:103], v[52:55]
    v_pk_mul_f16 v247, v103, v107 op_sel:[0,0] op_sel_hi:[1,0]
    v_pk_fma_f16 v106, v102, v106, v246 op_sel:[1,1,0] op_sel_hi:[0,1,1] neg_lo:[1,0,0]
    s_waitcnt lgkmcnt(5)
    v_mfma_f32_16x16x32_f16 v[60:63], v[112:115], v[100:103], v[60:63]
    v_pk_fma_f16 v107, v103, v107, v247 op_sel:[1,1,0] op_sel_hi:[0,1,1] neg_lo:[1,0,0]
    s_cmp_ge_u32 s8, 5
    s_cbranch_scc1 L_hfin
    s_setprio 3
    s_waitcnt lgkmcnt(0)
    v_readfirstlane_b32 s12, v255
    s_nop 0
    s_cmp_ge_u32 s12, 3
    s_cbranch_scc1 L_pollEP
L_pollP:
    s_sub_u32 s100, s100, 1
    s_cbranch_scc1 L_end
    s_sleep 1
    ds_read_b32 v255, v252 offset:2560
    s_waitcnt lgkmcnt(0)
    v_readfirstlane_b32 s12, v255
    s_nop 0
    s_cmp_lt_u32 s12, 3
    s_cbranch_scc1 L_pollP
L_pollEP:
    ds_read_b128 v[68:71], v241 offset:0
    ds_read_b128 v[72:75], v241 offset:1024
    ds_read_b128 v[76:79], v241 offset:2048
    ds_read_b128 v[80:83], v241 offset:3072
    ds_read_b128 v[200:203], v26 offset:0
    ds_read_b128 v[204:207], v26 offset:1024
    ds_read_b128 v[208:211], v26 offset:2048
    ds_read_b128 v[212:215], v26 offset:3072
    ds_add_u32 v252, v253 offset:2816
    ds_read_b32 v255, v252 offset:2048
    v_pk_mul_f16 v246, v116, v120 op_sel:[0,0] op_sel_hi:[1,0]
    v_mfma_f32_16x16x32_f16 v[56:59], v[108:111], v[104:107], v[56:59]
    v_pk_mul_f16 v247, v117, v121 op_sel:[0,0] op_sel_hi:[1,0]
    v_pk_fma_f16 v120, v116, v120, v246 op_sel:[1,1,0] op_sel_hi:[0,1,1] neg_lo:[1,0,0]
    v_mfma_f32_16x16x32_f16 v[64:67], v[112:115], v[104:107], v[64:67]
    v_pk_fma_f16 v121, v117, v121, v247 op_sel:[1,1,0] op_sel_hi:[0,1,1] neg_lo:[1,0,0]
    v_pk_mul_f16 v246, v118, v122 op_sel:[0,0] op_sel_hi:[1,0]
    v_mfma_f32_16x16x32_f16 v[52:55], v[124:127], v[116:119], v[52:55]
    v_pk_mul_f16 v247, v119, v123 op_sel:[0,0] op_sel_hi:[1,0]
    v_pk_fma_f16 v122, v118, v122, v246 op_sel:[1,1,0] op_sel_hi:[0,1,1] neg_lo:[1,0,0]
    v_mfma_f32_16x16x32_f16 v[60:63], v[128:131], v[116:119], v[60:63]
    v_pk_fma_f16 v123, v119, v123, v247 op_sel:[1,1,0] op_sel_hi:[0,1,1] neg_lo:[1,0,0]
    s_nop 1
    v_mfma_f32_16x16x32_f16 v[56:59], v[124:127], v[120:123], v[56:59]
    v_mfma_f32_16x16x32_f16 v[64:67], v[128:131], v[120:123], v[64:67]
    s_waitcnt lgkmcnt(0)
    s_cmp_lg_u32 s7, 0
    s_cbranch_scc1 L_npb
    v_readfirstlane_b32 s12, v255
    s_nop 0
    s_cmp_ge_u32 s12, 4
    s_cbranch_scc1 L_pollEA
L_pollA:
    s_sub_u32 s100, s100, 1
    s_cbranch_scc1 L_end
    s_sleep 1
    ds_read_b32 v255, v252 offset:2048
    s_waitcnt lgkmcnt(0)
    v_readfirstlane_b32 s12, v255
    s_nop 0
    s_cmp_lt_u32 s12, 4
    s_cbranch_scc1 L_pollA
L_pollEA:
    ds_read_b128 v[164:167], v220 offset:448
    ds_read_b128 v[168:171], v220 offset:432
    ds_read_b128 v[172:175], v220 offset:960
    ds_read_b128 v[176:179], v220 offset:944
    ds_read_b128 v[180:183], v220 offset:1472
    ds_read_b128 v[184:187], v220 offset:1456
    ds_read_b128 v[188:191], v220 offset:1984
    ds_read_b128 v[192:195], v220 offset:1968
L_npb:
    v_fma_f32 v52, v52, v237, v68
    v_fma_f32 v53, v53, v237, v69
    v_fma_f32 v54, v54, v237, v70
    v_fma_f32 v55, v55, v237, v71
    v_fma_f32 v60, v60, v237, v76
    v_fma_f32 v61, v61, v235, v77
    v_fma_f32 v62, v62, v235, v78
    v_fma_f32 v56, v56, v237, v72
    v_fma_f32 v57, v57, v237, v73
    v_fma_f32 v58, v58, v237, v74
    v_fma_f32 v59, v59, v237, v75
    v_fma_f32 v64, v64, v237, v80
    v_fma_f32 v65, v65, v235, v81
    v_fma_f32 v66, v66, v235, v82
    v_add_f32 v52, v52, v236
    v_mul_f32 v67, 0x3c000000, v66
    v_cvt_pk_bf16_f32 v84, v55, v54
    v_cvt_pk_bf16_f32 v85, v53, v52
    v_cvt_pk_bf16_f32 v86, v60, v55
    v_cvt_pk_bf16_f32 v87, v54, v53
    v_cvt_pk_bf16_f32 v92, v61, v62
    v_cvt_pk_bf16_f32 v96, v52, 0
    v_cvt_pk_bf16_f32 v88, v59, v58
    v_cvt_pk_bf16_f32 v89, v57, v56
    v_cvt_pk_bf16_f32 v90, v64, v59
    v_cvt_pk_bf16_f32 v91, v58, v57
    v_cvt_pk_bf16_f32 v93, v65, v66
    v_cvt_pk_bf16_f32 v94, 0, v64
    v_cvt_pk_bf16_f32 v95, v64, v64
    v_cvt_pk_bf16_f32 v97, v67, v67
    s_cmp_eq_u32 s7, 0
    s_cbranch_scc1 L_join
    v_min_u32 v84, -2, v84
    v_min_u32 v85, -2, v85
    v_min_u32 v86, -2, v86
    v_min_u32 v87, -2, v87
    global_store_dwordx4 v243, v[84:87], s[38:39] offset:0 sc1
    v_min_u32 v88, -2, v88
    v_min_u32 v89, -2, v89
    v_min_u32 v90, -2, v90
    v_min_u32 v91, -2, v91
    global_store_dwordx4 v243, v[88:91], s[38:39] offset:1024 sc1
    v_min_u32 v92, -2, v92
    v_min_u32 v93, -2, v93
    v_min_u32 v94, -2, v94
    v_min_u32 v95, -2, v95
    global_store_dwordx4 v243, v[92:95], s[38:39] offset:2048 sc1
    v_min_u32 v96, -2, v96
    v_min_u32 v97, -2, v97
    v_min_u32 v98, -2, v98
    v_min_u32 v99, -2, v99
    global_store_dwordx4 v243, v[96:99], s[38:39] offset:3072 sc1
    s_branch L_fin
L_join:
    ds_write_b64 v230, v[84:85] offset:256
    ds_write_b64 v230, v[86:87] offset:1472
    ds_write_b64 v230, v[88:89] offset:0
    ds_write_b64 v230, v[90:91] offset:1216
    s_mov_b64 exec, 1
    ds_write_b32 v227, v96 offset:2304
    s_mov_b64 exec, -1
    s_waitcnt lgkmcnt(12)
    v_mfma_f32_16x16x32_bf16 v[124:127], v[164:167], v[200:203], 0
    ds_read2_b32 v[0:1], v222 offset0:128 offset1:129
    ds_read2_b32 v[2:3], v222 offset0:130 offset1:131
    v_mfma_f32_16x16x32_bf16 v[108:111], v[164:167], v[204:207], 0
    ds_read2_b32 v[32:33], v222 offset0:0 offset1:1
    ds_read2_b32 v[34:35], v222 offset0:2 offset1:3
    s_waitcnt lgkmcnt(15)
    v_mfma_f32_16x16x32_bf16 v[128:131], v[168:171], v[200:203], 0
    ds_read2_b32 v[4:5], v222 offset0:112 offset1:113
    ds_read2_b32 v[6:7], v222 offset0:114 offset1:115
    v_mfma_f32_16x16x32_bf16 v[112:115], v[168:171], v[204:207], 0
    ds_read2_b32 v[36:37], v221 offset0:112 offset1:113
    ds_read2_b32 v[38:39], v221 offset0:114 offset1:115
    v_mfma_f32_16x16x32_bf16 v[148:151], v[164:167], v[208:211], 0
    ds_read2_b32 v[8:9], v222 offset0:96 offset1:97
    ds_read2_b32 v[10:11], v222 offset0:98 offset1:99
    v_mfma_f32_16x16x32_bf16 v[116:119], v[168:171], v[212:215], 0
    ds_read2_b32 v[40:41], v221 offset0:96 offset1:97
    ds_read2_b32 v[42:43], v221 offset0:98 offset1:99
    s_waitcnt lgkmcnt(15)
    v_mfma_f32_16x16x32_bf16 v[132:135], v[172:175], v[200:203], 0
    ds_read2_b32 v[12:13], v222 offset0:80 offset1:81
    ds_read2_b32 v[14:15], v222 offset0:82 offset1:83
    v_cvt_pk_bf16_f32 v124, v124, v125
    v_cvt_pk_bf16_f32 v125, v126, v127
    v_mfma_f32_16x16x32_bf16 v[120:123], v[172:175], v[204:207], 0
    ds_read2_b32 v[44:45], v221 offset0:80 offset1:81
    ds_read2_b32 v[46:47], v221 offset0:82 offset1:83
    v_cvt_pk_bf16_f32 v126, v108, v109
    v_cvt_pk_bf16_f32 v127, v110, v111
    v_mfma_f32_16x16x32_bf16 v[136:139], v[176:179], v[200:203], 0
    ds_read2_b32 v[16:17], v222 offset0:64 offset1:65
    ds_read2_b32 v[18:19], v222 offset0:66 offset1:67
    v_cvt_pk_bf16_f32 v128, v128, v129
    v_cvt_pk_bf16_f32 v129, v130, v131
    v_mfma_f32_16x16x32_bf16 v[196:199], v[176:179], v[204:207], 0
    ds_read2_b32 v[48:49], v221 offset0:64 offset1:65
    ds_read2_b32 v[50:51], v221 offset0:66 offset1:67
    v_cvt_pk_bf16_f32 v130, v112, v113
    v_cvt_pk_bf16_f32 v131, v114, v115
    v_mfma_f32_16x16x32_bf16 v[152:155], v[172:175], v[208:211], 0
    ds_read2_b32 v[20:21], v222 offset0:48 offset1:49
    ds_read2_b32 v[22:23], v222 offset0:50 offset1:51
    v_cvt_pk_bf16_f32 v148, v148, v149
    v_cvt_pk_bf16_f32 v149, v150, v151
    v_mfma_f32_16x16x32_bf16 v[244:247], v[176:179], v[212:215], 0
    ds_read2_b32 v[52:53], v221 offset0:48 offset1:49
    ds_read2_b32 v[54:55], v221 offset0:50 offset1:51
    v_cvt_pk_bf16_f32 v150, v116, v117
    v_cvt_pk_bf16_f32 v151, v118, v119
    v_mfma_f32_16x16x32_bf16 v[140:143], v[180:183], v[200:203], 0
    ds_read2_b32 v[24:25], v222 offset0:32 offset1:33
    ds_read2_b32 v[26:27], v222 offset0:34 offset1:35
    v_cvt_pk_bf16_f32 v132, v132, v133
    v_cvt_pk_bf16_f32 v133, v134, v135
    v_mfma_f32_16x16x32_bf16 v[108:111], v[180:183], v[204:207], 0
    ds_read2_b32 v[56:57], v221 offset0:32 offset1:33
    ds_read2_b32 v[58:59], v221 offset0:34 offset1:35
    v_cvt_pk_bf16_f32 v134, v120, v121
    v_cvt_pk_bf16_f32 v135, v122, v123
    v_mfma_f32_16x16x32_bf16 v[144:147], v[184:187], v[200:203], 0
    ds_read2_b32 v[28:29], v222 offset0:16 offset1:17
    ds_read2_b32 v[30:31], v222 offset0:18 offset1:19
    v_cvt_pk_bf16_f32 v136, v136, v137
    v_cvt_pk_bf16_f32 v137, v138, v139
    v_mfma_f32_16x16x32_bf16 v[112:115], v[184:187], v[204:207], 0
    ds_read2_b32 v[60:61], v221 offset0:16 offset1:17
    ds_read2_b32 v[62:63], v221 offset0:18 offset1:19
    v_cvt_pk_bf16_f32 v138, v196, v197
    v_cvt_pk_bf16_f32 v139, v198, v199
    v_mfma_f32_16x16x32_bf16 v[156:159], v[180:183], v[208:211], 0
    ds_read_b128 v[164:167], v220 offset:448
    ds_read_b128 v[168:171], v220 offset:384
    v_cvt_pk_bf16_f32 v152, v152, v153
    v_cvt_pk_bf16_f32 v153, v154, v155
    v_mfma_f32_16x16x32_bf16 v[116:119], v[184:187], v[212:215], 0
    ds_read_b128 v[172:175], v220 offset:320
    ds_read_b128 v[176:179], v220 offset:256
    v_cvt_pk_bf16_f32 v154, v244, v245
    v_cvt_pk_bf16_f32 v155, v246, v247
    v_mfma_f32_16x16x32_bf16 v[160:163], v[188:191], v[208:211], 0
    ds_read_b128 v[180:183], v220 offset:192
    ds_read_b128 v[184:187], v220 offset:128
    v_cvt_pk_bf16_f32 v140, v140, v141
    v_cvt_pk_bf16_f32 v141, v142, v143
    v_mfma_f32_16x16x32_bf16 v[120:123], v[192:195], v[212:215], 0
    ds_read_b128 v[188:191], v220 offset:64
    ds_read_b128 v[192:195], v220 offset:0
    v_cvt_pk_bf16_f32 v142, v108, v109
    v_cvt_pk_bf16_f32 v143, v110, v111
    v_cvt_pk_bf16_f32 v144, v144, v145
    v_cvt_pk_bf16_f32 v145, v146, v147
    v_cvt_pk_bf16_f32 v146, v112, v113
    v_cvt_pk_bf16_f32 v147, v114, v115
    v_cvt_pk_bf16_f32 v156, v156, v157
    v_cvt_pk_bf16_f32 v157, v158, v159
    v_cvt_pk_bf16_f32 v158, v116, v117
    v_cvt_pk_bf16_f32 v159, v118, v119
    v_cvt_pk_bf16_f32 v160, v160, v161
    v_cvt_pk_bf16_f32 v161, v162, v163
    v_cvt_pk_bf16_f32 v162, v120, v121
    v_cvt_pk_bf16_f32 v163, v122, v123
L_conv:
    s_lshl_b32 s13, s101, 8
    v_add_u32 v229, s13, v252
    s_setprio 3
    s_waitcnt lgkmcnt(7)
    v_mfma_f32_16x16x32_bf16 v[108:111], v[0:3], v[164:167], 0
    s_mov_b32 exec_lo, 0
    s_mov_b32 exec_hi, 0x80000000
    ds_write_b64 v227, v[94:95] offset:56
    ds_write_b32 v227, v95 offset:1276
    s_mov_b64 exec, -1
    v_mfma_f32_16x16x32_bf16 v[112:115], v[32:35], v[164:167], 0
    ds_read_b128 v[164:167], v220 offset:960
    s_waitcnt lgkmcnt(9)
    v_mfma_f32_16x16x32_bf16 v[108:111], v[4:7], v[168:171], v[108:111]
    ds_write_b16 v228, v92 offset:48
    ds_write_b16_d16_hi v228, v92 offset:16
    v_mfma_f32_16x16x32_bf16 v[112:115], v[36:39], v[168:171], v[112:115]
    ds_read_b128 v[168:171], v220 offset:896
    s_waitcnt lgkmcnt(11)
    v_mfma_f32_16x16x32_bf16 v[108:111], v[8:11], v[172:175], v[108:111]
    ds_write_b16 v228, v93 offset:32
    ds_write_b16_d16_hi v228, v93 offset:0
    v_mfma_f32_16x16x32_bf16 v[112:115], v[40:43], v[172:175], v[112:115]
    ds_read_b128 v[172:175], v220 offset:832
    s_waitcnt lgkmcnt(13)
    v_mfma_f32_16x16x32_bf16 v[108:111], v[12:15], v[176:179], v[108:111]
    ds_write_b16 v228, v92 offset:882
    ds_write_b16_d16_hi v228, v92 offset:850
    v_mfma_f32_16x16x32_bf16 v[112:115], v[44:47], v[176:179], v[112:115]
    ds_read_b128 v[176:179], v220 offset:768
    s_waitcnt lgkmcnt(15)
    v_mfma_f32_16x16x32_bf16 v[108:111], v[16:19], v[180:183], v[108:111]
    ds_write_b16 v228, v93 offset:866
    ds_write_b16_d16_hi v228, v93 offset:834
    v_readlane_b32 s59, v97, 31
    v_mfma_f32_16x16x32_bf16 v[112:115], v[48:51], v[180:183], v[112:115]
    ds_read_b128 v[180:183], v220 offset:704
    s_waitcnt lgkmcnt(15)
    v_mfma_f32_16x16x32_bf16 v[108:111], v[20:23], v[184:187], v[108:111]
    ds_read2_b32 v[64:65], v221 offset0:0 offset1:1
    v_mfma_f32_16x16x32_bf16 v[112:115], v[52:55], v[184:187], v[112:115]
    ds_read_b128 v[184:187], v220 offset:640
    v_mfma_f32_16x16x32_bf16 v[108:111], v[24:27], v[188:191], v[108:111]
    ds_read2_b32 v[66:67], v221 offset0:2 offset1:3
    v_mfma_f32_16x16x32_bf16 v[112:115], v[56:59], v[188:191], v[112:115]
    ds_read_b128 v[188:191], v220 offset:576
    v_mfma_f32_16x16x32_bf16 v[108:111], v[28:31], v[192:195], v[108:111]
    ds_read2_b32 v[68:69], v223 offset0:16 offset1:17
    v_mfma_f32_16x16x32_bf16 v[112:115], v[60:63], v[192:195], v[112:115]
    ds_read_b128 v[192:195], v220 offset:512
    s_waitcnt lgkmcnt(15)
    v_mfma_f32_16x16x32_bf16 v[112:115], v[0:3], v[164:167], v[112:115]
    ds_read2_b32 v[70:71], v223 offset0:48 offset1:49
    v_mfma_f32_16x16x32_bf16 v[116:119], v[32:35], v[164:167], 0
    ds_read_b128 v[164:167], v220 offset:448
    v_mfma_f32_16x16x32_bf16 v[112:115], v[4:7], v[168:171], v[112:115]
    ds_read2_b32 v[72:73], v223 offset0:80 offset1:81
    v_mfma_f32_16x16x32_bf16 v[116:119], v[36:39], v[168:171], v[116:119]
    ds_read_b128 v[168:171], v220 offset:1472
    s_waitcnt lgkmcnt(15)
    v_mfma_f32_16x16x32_bf16 v[112:115], v[8:11], v[172:175], v[112:115]
    v_cvt_pk_bf16_f32 v248, v108, v109
    v_cvt_pk_bf16_f32 v249, v110, v111
    v_mfma_f32_16x16x32_bf16 v[116:119], v[40:43], v[172:175], v[116:119]
    ds_read_b128 v[172:175], v220 offset:1408
    s_waitcnt lgkmcnt(14)
    v_mfma_f32_16x16x32_bf16 v[112:115], v[12:15], v[176:179], v[112:115]
    ds_write_b64 v224, v[248:249] offset:0
    v_mfma_f32_16x16x32_bf16 v[116:119], v[44:47], v[176:179], v[116:119]
    ds_read_b128 v[176:179], v220 offset:1344
    s_waitcnt lgkmcnt(13)
    v_mfma_f32_16x16x32_bf16 v[112:115], v[16:19], v[180:183], v[112:115]
    ds_add_u32 v252, v253 offset:0
    v_mfma_f32_16x16x32_bf16 v[116:119], v[48:51], v[180:183], v[116:119]
    ds_read_b128 v[180:183], v220 offset:1280
    s_waitcnt lgkmcnt(13)
    v_mfma_f32_16x16x32_bf16 v[112:115], v[20:23], v[184:187], v[112:115]
    ds_read2_b32 v[74:75], v223 offset0:112 offset1:113
    v_mfma_f32_16x16x32_bf16 v[116:119], v[52:55], v[184:187], v[116:119]
    ds_read_b128 v[184:187], v220 offset:1216
    s_waitcnt lgkmcnt(13)
    v_mfma_f32_16x16x32_bf16 v[112:115], v[24:27], v[188:191], v[112:115]
    ds_read_b32 v255, v252 offset:2304
    v_mfma_f32_16x16x32_bf16 v[116:119], v[56:59], v[188:191], v[116:119]
    ds_read_b128 v[188:191], v220 offset:1152
    s_waitcnt lgkmcnt(13)
    v_mfma_f32_16x16x32_bf16 v[112:115], v[28:31], v[192:195], v[112:115]
    ds_read2_b32 v[76:77], v223 offset0:8 offset1:9
    v_mfma_f32_16x16x32_bf16 v[116:119], v[60:63], v[192:195], v[116:119]
    ds_read_b128 v[192:195], v220 offset:1088
    s_waitcnt lgkmcnt(13)
    v_mfma_f32_16x16x32_bf16 v[116:119], v[64:67], v[164:167], v[116:119]
    ds_read_b128 v[164:167], v220 offset:1024
    s_waitcnt lgkmcnt(12)
    v_mfma_f32_16x16x32_bf16 v[116:119], v[0:3], v[168:171], v[116:119]
    ds_read2_b32 v[78:79], v223 offset0:40 offset1:41
    v_mfma_f32_16x16x32_bf16 v[120:123], v[32:35], v[168:171], 0
    ds_read_b128 v[168:171], v220 offset:960
    s_waitcnt lgkmcnt(13)
    v_mfma_f32_16x16x32_bf16 v[116:119], v[4:7], v[172:175], v[116:119]
    v_cvt_pk_bf16_f32 v250, v112, v113
    v_cvt_pk_bf16_f32 v251, v114, v115
    v_mfma_f32_16x16x32_bf16 v[120:123], v[36:39], v[172:175], v[120:123]
    ds_read_b128 v[172:175], v220 offset:1984
    s_waitcnt lgkmcnt(12)
    v_mfma_f32_16x16x32_bf16 v[116:119], v[8:11], v[176:179], v[116:119]
    ds_write_b64 v224, v[250:251] offset:512
    v_mfma_f32_16x16x32_bf16 v[120:123], v[40:43], v[176:179], v[120:123]
    ds_read_b128 v[176:179], v220 offset:1920
    ds_read_b32 v254, v229
    s_waitcnt lgkmcnt(13)
    v_mfma_f32_16x16x32_bf16 v[116:119], v[12:15], v[180:183], v[116:119]
    ds_add_u32 v252, v253 offset:256
    v_mfma_f32_16x16x32_bf16 v[120:123], v[44:47], v[180:183], v[120:123]
    ds_read_b128 v[180:183], v220 offset:1856
    s_waitcnt lgkmcnt(13)
    v_mfma_f32_16x16x32_bf16 v[116:119], v[16:19], v[184:187], v[116:119]
    ds_read2_b32 v[80:81], v223 offset0:72 offset1:73
    v_mfma_f32_16x16x32_bf16 v[120:123], v[48:51], v[184:187], v[120:123]
    ds_read_b128 v[184:187], v220 offset:1792
    s_waitcnt lgkmcnt(13)
    v_mfma_f32_16x16x32_bf16 v[116:119], v[20:23], v[188:191], v[116:119]
    ds_read2_b32 v[82:83], v223 offset0:104 offset1:105
    s_waitcnt lgkmcnt(5)
    v_readfirstlane_b32 s13, v254
    s_nop 0
    s_cmp_lt_u32 s13, 8
    s_cbranch_scc1 L_ns2_6
    ds_read_b64_tr_b16 v[232:233], v225
    ds_read_b64_tr_b16 v[234:235], v225 offset:45312
L_ns2_6:
    v_mfma_f32_16x16x32_bf16 v[120:123], v[52:55], v[188:191], v[120:123]
    ds_read_b128 v[188:191], v220 offset:1728
    v_mfma_f32_16x16x32_bf16 v[116:119], v[24:27], v[192:195], v[116:119]
    ds_read2_b32 v[84:85], v223 offset0:0 offset1:1
    v_mfma_f32_16x16x32_bf16 v[120:123], v[56:59], v[192:195], v[120:123]
    ds_read_b128 v[192:195], v220 offset:1664
    v_mfma_f32_16x16x32_bf16 v[116:119], v[28:31], v[164:167], v[116:119]
    ds_read2_b32 v[86:87], v223 offset0:32 offset1:33
    v_mfma_f32_16x16x32_bf16 v[116:119], v[124:127], v[68:71], v[116:119]
    s_cmp_lt_u32 s13, 8
    s_cbranch_scc1 L_nt2_6
    s_waitcnt lgkmcnt(4)
    buffer_store_dwordx4 v[232:235], v226, s[44:47], s14 offen
    v_add_u32 v229, 512, v229
    v_add_u32 v225, 1024, v225
    s_add_u32 s14, s14, 1310720
    s_add_u32 s101, s101, 2
L_nt2_6:
    v_mfma_f32_16x16x32_bf16 v[116:119], v[128:131], v[72:75], v[116:119]
    ds_read2_b32 v[88:89], v223 offset0:64 offset1:65
    v_mfma_f32_16x16x32_bf16 v[120:123], v[60:63], v[164:167], v[120:123]
    ds_read_b128 v[164:167], v220 offset:1600
    s_setprio 2
    v_mfma_f32_16x16x32_bf16 v[120:123], v[64:67], v[168:171], v[120:123]
    ds_read_b128 v[168:171], v220 offset:1536
    v_mfma_f32_16x16x32_bf16 v[120:123], v[0:3], v[172:175], v[120:123]
    ds_read2_b32 v[90:91], v223 offset0:96 offset1:97
    v_mfma_f32_16x16x32_bf16 v[108:111], v[32:35], v[172:175], 0
    ds_read_b128 v[172:175], v220 offset:1472
    v_mfma_f32_16x16x32_bf16 v[120:123], v[4:7], v[176:179], v[120:123]
    v_cvt_pk_bf16_f32 v248, v116, v117
    v_cvt_pk_bf16_f32 v249, v118, v119
    v_mfma_f32_16x16x32_bf16 v[108:111], v[36:39], v[176:179], v[108:111]
    ds_read_b128 v[176:179], v220 offset:448
    s_waitcnt lgkmcnt(13)
    v_mfma_f32_16x16x32_bf16 v[120:123], v[8:11], v[180:183], v[120:123]
    ds_write_b64 v224, v[248:249] offset:1024
    v_mfma_f32_16x16x32_bf16 v[108:111], v[40:43], v[180:183], v[108:111]
    v_readfirstlane_b32 s12, v255
    s_nop 0
    s_cmp_ge_u32 s12, 16
    s_cbranch_scc1 L_pollEB
L_pollB:
    s_sub_u32 s100, s100, 1
    s_cbranch_scc1 L_end
    s_sleep 1
    ds_read_b32 v255, v252 offset:2304
    s_waitcnt lgkmcnt(0)
    v_readfirstlane_b32 s12, v255
    s_nop 0
    s_cmp_lt_u32 s12, 16
    s_cbranch_scc1 L_pollB
L_pollEB:
    ds_read_b128 v[180:183], v220 offset:2496
    s_waitcnt lgkmcnt(13)
    v_mfma_f32_16x16x32_bf16 v[120:123], v[12:15], v[184:187], v[120:123]
    ds_add_u32 v252, v253 offset:512
    v_mfma_f32_16x16x32_bf16 v[108:111], v[44:47], v[184:187], v[108:111]
    ds_read_b128 v[184:187], v220 offset:2432
    ds_read_b32 v254, v229
    s_waitcnt lgkmcnt(14)
    v_mfma_f32_16x16x32_bf16 v[120:123], v[16:19], v[188:191], v[120:123]
    v_bitop3_b32 v216, v200, v208, v208 bitop3:0x30
    v_bitop3_b32 v217, v201, v209, v209 bitop3:0x30
    v_mfma_f32_16x16x32_bf16 v[108:111], v[48:51], v[188:191], v[108:111]
    ds_read_b128 v[188:191], v220 offset:2368
    s_waitcnt lgkmcnt(13)
    v_mfma_f32_16x16x32_bf16 v[120:123], v[20:23], v[192:195], v[120:123]
    v_bitop3_b32 v218, v202, v210, v210 bitop3:0x30
    v_bitop3_b32 v219, v203, v211, v211 bitop3:0x30
    v_mfma_f32_16x16x32_bf16 v[108:111], v[52:55], v[192:195], v[108:111]
    ds_read_b128 v[192:195], v220 offset:2304
    s_waitcnt lgkmcnt(11)
    v_mfma_f32_16x16x32_bf16 v[120:123], v[24:27], v[164:167], v[120:123]
    v_pk_mul_f16 v216, v216, s59
    v_pk_mul_f16 v217, v217, s59
    s_waitcnt lgkmcnt(2)
    v_readfirstlane_b32 s13, v254
    s_nop 0
    s_cmp_lt_u32 s13, 8
    s_cbranch_scc1 L_ns3_8
    ds_read_b64_tr_b16 v[232:233], v225
    ds_read_b64_tr_b16 v[234:235], v225 offset:45312
L_ns3_8:
    v_mfma_f32_16x16x32_bf16 v[108:111], v[56:59], v[164:167], v[108:111]
    ds_read_b128 v[164:167], v220 offset:2240
    v_mfma_f32_16x16x32_bf16 v[120:123], v[28:31], v[168:171], v[120:123]
    v_pk_mul_f16 v218, v218, s59
    v_pk_mul_f16 v219, v219, s59
    v_mfma_f32_16x16x32_bf16 v[120:123], v[124:127], v[76:79], v[120:123]
    ds_read2_b32 v[92:93], v223 offset0:152 offset1:153
    v_mfma_f32_16x16x32_bf16 v[120:123], v[128:131], v[80:83], v[120:123]
    v_mfma_f32_16x16x32_bf16 v[120:123], v[132:135], v[68:71], v[120:123]
    ds_read2_b32 v[94:95], v223 offset0:192 offset1:193
    s_cmp_lt_u32 s13, 8
    s_cbranch_scc1 L_nt3_8
    s_waitcnt lgkmcnt(3)
    buffer_store_dwordx4 v[232:235], v226, s[44:47], s14 offen
    v_add_u32 v229, 512, v229
    v_add_u32 v225, 1024, v225
    s_add_u32 s14, s14, 1310720
    s_add_u32 s101, s101, 2
L_nt3_8:
    v_mfma_f32_16x16x32_bf16 v[120:123], v[136:139], v[72:75], v[120:123]
    ds_read_b32 v255, v252 offset:2304
    v_mfma_f32_16x16x32_bf16 v[108:111], v[60:63], v[168:171], v[108:111]
    ds_read_b128 v[168:171], v220 offset:2176
    v_mfma_f32_16x16x32_bf16 v[108:111], v[64:67], v[172:175], v[108:111]
    ds_read_b128 v[172:175], v220 offset:2112
    v_mfma_f32_16x16x32_bf16 v[108:111], v[216:219], v[176:179], v[108:111]
    ds_read_b128 v[176:179], v220 offset:2048
    v_mfma_f32_16x16x32_bf16 v[108:111], v[0:3], v[180:183], v[108:111]
    ds_read2_b32 v[96:97], v223 offset0:144 offset1:145
    v_mfma_f32_16x16x32_bf16 v[112:115], v[32:35], v[180:183], 0
    ds_read_b128 v[180:183], v220 offset:1984
    v_mfma_f32_16x16x32_bf16 v[108:111], v[4:7], v[184:187], v[108:111]
    v_cvt_pk_bf16_f32 v250, v120, v121
    v_cvt_pk_bf16_f32 v251, v122, v123
    v_mfma_f32_16x16x32_bf16 v[112:115], v[36:39], v[184:187], v[112:115]
    ds_read_b128 v[184:187], v220 offset:1968
    s_waitcnt lgkmcnt(11)
    v_mfma_f32_16x16x32_bf16 v[108:111], v[8:11], v[188:191], v[108:111]
    ds_write_b64 v224, v[250:251] offset:1536
    v_mfma_f32_16x16x32_bf16 v[112:115], v[40:43], v[188:191], v[112:115]
    ds_read_b128 v[188:191], v220 offset:960
    s_waitcnt lgkmcnt(12)
    v_mfma_f32_16x16x32_bf16 v[108:111], v[12:15], v[192:195], v[108:111]
    ds_add_u32 v252, v253 offset:768
    v_mfma_f32_16x16x32_bf16 v[112:115], v[44:47], v[192:195], v[112:115]
    s_waitcnt lgkmcnt(9)
    v_readfirstlane_b32 s12, v255
    s_nop 0
    s_cmp_ge_u32 s12, 19
    s_cbranch_scc1 L_pollEC
L_pollC:
    s_sub_u32 s100, s100, 1
    s_cbranch_scc1 L_end
    s_sleep 1
    ds_read_b32 v255, v252 offset:2304
    s_waitcnt lgkmcnt(0)
    v_readfirstlane_b32 s12, v255
    s_nop 0
    s_cmp_lt_u32 s12, 19
    s_cbranch_scc1 L_pollC
L_pollEC:
    ds_read_b128 v[192:195], v220 offset:3008
    v_mfma_f32_16x16x32_bf16 v[108:111], v[16:19], v[164:167], v[108:111]
    ds_read2_b32 v[98:99], v223 offset0:184 offset1:185
    v_mfma_f32_16x16x32_bf16 v[112:115], v[48:51], v[164:167], v[112:115]
    ds_read_b128 v[164:167], v220 offset:2944
    s_waitcnt lgkmcnt(11)
    v_mfma_f32_16x16x32_bf16 v[108:111], v[20:23], v[168:171], v[108:111]
    ds_read2_b32 v[100:101], v223 offset0:136 offset1:137
    ds_read_b32 v254, v229
    v_mfma_f32_16x16x32_bf16 v[112:115], v[52:55], v[168:171], v[112:115]
    ds_read_b128 v[168:171], v220 offset:2880
    s_waitcnt lgkmcnt(13)
    v_mfma_f32_16x16x32_bf16 v[108:111], v[24:27], v[172:175], v[108:111]
    ds_read2_b32 v[102:103], v223 offset0:176 offset1:177
    v_mfma_f32_16x16x32_bf16 v[112:115], v[56:59], v[172:175], v[112:115]
    ds_read_b128 v[172:175], v220 offset:2816
    s_waitcnt lgkmcnt(14)
    v_mfma_f32_16x16x32_bf16 v[108:111], v[28:31], v[176:179], v[108:111]
    ds_read2_b32 v[104:105], v223 offset0:128 offset1:129
    v_mfma_f32_16x16x32_bf16 v[108:111], v[124:127], v[84:87], v[108:111]
    s_waitcnt lgkmcnt(4)
    v_readfirstlane_b32 s13, v254
    s_nop 0
    s_cmp_lt_u32 s13, 8
    s_cbranch_scc1 L_ns4_12
    ds_read_b64_tr_b16 v[232:233], v225
    ds_read_b64_tr_b16 v[234:235], v225 offset:45312
L_ns4_12:
    v_mfma_f32_16x16x32_bf16 v[108:111], v[128:131], v[88:91], v[108:111]
    ds_read2_b32 v[106:107], v223 offset0:168 offset1:169
    v_mfma_f32_16x16x32_bf16 v[108:111], v[132:135], v[76:79], v[108:111]
    v_mfma_f32_16x16x32_bf16 v[108:111], v[136:139], v[80:83], v[108:111]
    v_mfma_f32_16x16x32_bf16 v[108:111], v[140:143], v[68:71], v[108:111]
    v_mfma_f32_16x16x32_bf16 v[108:111], v[144:147], v[72:75], v[108:111]
    s_cmp_lt_u32 s13, 8
    s_cbranch_scc1 L_nt4_12
    s_waitcnt lgkmcnt(1)
    buffer_store_dwordx4 v[232:235], v226, s[44:47], s14 offen
    v_add_u32 v229, 512, v229
    v_add_u32 v225, 1024, v225
    s_add_u32 s14, s14, 1310720
    s_add_u32 s101, s101, 2
L_nt4_12:
    v_mfma_f32_16x16x32_bf16 v[108:111], v[148:151], v[92:95], v[108:111]
    v_mfma_f32_16x16x32_bf16 v[112:115], v[60:63], v[176:179], v[112:115]
    ds_read_b128 v[176:179], v220 offset:2752
    s_setprio 1
    v_mfma_f32_16x16x32_bf16 v[124:127], v[180:183], v[200:203], 0
    v_mfma_f32_16x16x32_bf16 v[196:199], v[180:183], v[204:207], 0
    v_mfma_f32_16x16x32_bf16 v[112:115], v[64:67], v[180:183], v[112:115]
    ds_read_b128 v[180:183], v220 offset:2688
    v_mfma_f32_16x16x32_bf16 v[128:131], v[184:187], v[200:203], 0
    v_cvt_pk_bf16_f32 v248, v108, v109
    v_cvt_pk_bf16_f32 v249, v110, v111
    v_mfma_f32_16x16x32_bf16 v[240:243], v[184:187], v[204:207], 0
    ds_read_b128 v[184:187], v220 offset:2624
    v_mfma_f32_16x16x32_bf16 v[112:115], v[216:219], v[188:191], v[112:115]
    ds_read_b128 v[188:191], v220 offset:2560
    v_mfma_f32_16x16x32_bf16 v[112:115], v[132:135], v[84:87], v[112:115]
    ds_write_b64 v224, v[248:249] offset:2048
    v_mfma_f32_16x16x32_bf16 v[112:115], v[136:139], v[88:91], v[112:115]
    ds_add_u32 v252, v253 offset:1024
    v_mfma_f32_16x16x32_bf16 v[112:115], v[140:143], v[76:79], v[112:115]
    v_cvt_pk_bf16_f32 v124, v124, v125
    v_cvt_pk_bf16_f32 v125, v126, v127
    v_mfma_f32_16x16x32_bf16 v[112:115], v[144:147], v[80:83], v[112:115]
    v_cvt_pk_bf16_f32 v126, v196, v197
    v_cvt_pk_bf16_f32 v127, v198, v199
    v_mfma_f32_16x16x32_bf16 v[112:115], v[148:151], v[96:99], v[112:115]
    v_cvt_pk_bf16_f32 v128, v128, v129
    v_mfma_f32_16x16x32_bf16 v[112:115], v[0:3], v[192:195], v[112:115]
    v_cvt_pk_bf16_f32 v129, v130, v131
    v_cvt_pk_bf16_f32 v130, v240, v241
    v_mfma_f32_16x16x32_bf16 v[116:119], v[32:35], v[192:195], 0
    ds_read_b128 v[192:195], v220 offset:2496
    ds_read_b32 v254, v229
    v_mfma_f32_16x16x32_bf16 v[112:115], v[4:7], v[164:167], v[112:115]
    v_cvt_pk_bf16_f32 v131, v242, v243
    v_mfma_f32_16x16x32_bf16 v[116:119], v[36:39], v[164:167], v[116:119]
    ds_read_b128 v[164:167], v220 offset:2480
    s_waitcnt lgkmcnt(13)
    v_mfma_f32_16x16x32_bf16 v[112:115], v[8:11], v[168:171], v[112:115]
    v_mfma_f32_16x16x32_bf16 v[116:119], v[40:43], v[168:171], v[116:119]
    ds_read_b128 v[168:171], v220 offset:1472
    s_waitcnt lgkmcnt(12)
    v_mfma_f32_16x16x32_bf16 v[112:115], v[12:15], v[172:175], v[112:115]
    s_waitcnt lgkmcnt(2)
    v_readfirstlane_b32 s13, v254
    s_nop 0
    s_cmp_lt_u32 s13, 8
    s_cbranch_scc1 L_ns5_12
    ds_read_b64_tr_b16 v[232:233], v225
    ds_read_b64_tr_b16 v[234:235], v225 offset:45312
L_ns5_12:
    v_mfma_f32_16x16x32_bf16 v[116:119], v[44:47], v[172:175], v[116:119]
    ds_read_b128 v[172:175], v220 offset:3520
    v_mfma_f32_16x16x32_bf16 v[112:115], v[16:19], v[176:179], v[112:115]
    v_mfma_f32_16x16x32_bf16 v[116:119], v[48:51], v[176:179], v[116:119]
    ds_read_b128 v[176:179], v220 offset:3456
    v_mfma_f32_16x16x32_bf16 v[112:115], v[20:23], v[180:183], v[112:115]
    v_mfma_f32_16x16x32_bf16 v[116:119], v[52:55], v[180:183], v[116:119]
    ds_read_b128 v[180:183], v220 offset:3392
    s_cmp_lt_u32 s13, 8
    s_cbranch_scc1 L_nt5_12
    s_waitcnt lgkmcnt(3)
    buffer_store_dwordx4 v[232:235], v226, s[44:47], s14 offen
    v_add_u32 v229, 512, v229
    v_add_u32 v225, 1024, v225
    s_add_u32 s14, s14, 1310720
    s_add_u32 s101, s101, 2
L_nt5_12:
    v_mfma_f32_16x16x32_bf16 v[112:115], v[24:27], v[184:187], v[112:115]
    v_mfma_f32_16x16x32_bf16 v[116:119], v[56:59], v[184:187], v[116:119]
    ds_read_b128 v[184:187], v220 offset:3328
    v_mfma_f32_16x16x32_bf16 v[112:115], v[28:31], v[188:191], v[112:115]
    v_mfma_f32_16x16x32_bf16 v[112:115], v[124:127], v[68:71], v[112:115]
    v_mfma_f32_16x16x32_bf16 v[112:115], v[128:131], v[72:75], v[112:115]
    v_mfma_f32_16x16x32_bf16 v[112:115], v[152:155], v[92:95], v[112:115]
    v_mfma_f32_16x16x32_bf16 v[116:119], v[60:63], v[188:191], v[116:119]
    ds_read_b128 v[188:191], v220 offset:3264
    v_mfma_f32_16x16x32_bf16 v[132:135], v[192:195], v[200:203], 0
    v_mfma_f32_16x16x32_bf16 v[196:199], v[192:195], v[204:207], 0
    ds_read_b32 v254, v229
    v_mfma_f32_16x16x32_bf16 v[116:119], v[64:67], v[192:195], v[116:119]
    ds_read_b128 v[192:195], v220 offset:3200
    s_waitcnt lgkmcnt(8)
    v_mfma_f32_16x16x32_bf16 v[136:139], v[164:167], v[200:203], 0
    v_cvt_pk_bf16_f32 v250, v112, v113
    v_cvt_pk_bf16_f32 v251, v114, v115
    v_mfma_f32_16x16x32_bf16 v[240:243], v[164:167], v[204:207], 0
    ds_read_b128 v[164:167], v220 offset:3136
    s_waitcnt lgkmcnt(8)
    v_mfma_f32_16x16x32_bf16 v[116:119], v[216:219], v[168:171], v[116:119]
    ds_read_b128 v[168:171], v220 offset:3072
    v_mfma_f32_16x16x32_bf16 v[116:119], v[140:143], v[84:87], v[116:119]
    ds_write_b64 v224, v[250:251] offset:2560
    s_waitcnt lgkmcnt(4)
    v_readfirstlane_b32 s13, v254
    s_nop 0
    s_cmp_lt_u32 s13, 8
    s_cbranch_scc1 L_ns6_1
    ds_read_b64_tr_b16 v[232:233], v225
    ds_read_b64_tr_b16 v[234:235], v225 offset:45312
L_ns6_1:
    v_mfma_f32_16x16x32_bf16 v[116:119], v[144:147], v[88:91], v[116:119]
    ds_add_u32 v252, v253 offset:1280
    v_mfma_f32_16x16x32_bf16 v[116:119], v[124:127], v[76:79], v[116:119]
    v_cvt_pk_bf16_f32 v132, v132, v133
    v_cvt_pk_bf16_f32 v133, v134, v135
    v_mfma_f32_16x16x32_bf16 v[116:119], v[128:131], v[80:83], v[116:119]
    v_cvt_pk_bf16_f32 v134, v196, v197
    v_cvt_pk_bf16_f32 v135, v198, v199
    v_mfma_f32_16x16x32_bf16 v[116:119], v[148:151], v[100:103], v[116:119]
    v_cvt_pk_bf16_f32 v136, v136, v137
    v_cvt_pk_bf16_f32 v137, v138, v139
    v_mfma_f32_16x16x32_bf16 v[116:119], v[152:155], v[96:99], v[116:119]
    v_cvt_pk_bf16_f32 v138, v240, v241
    s_cmp_lt_u32 s13, 8
    s_cbranch_scc1 L_nt6_1
    s_waitcnt lgkmcnt(1)
    buffer_store_dwordx4 v[232:235], v226, s[44:47], s14 offen
    v_add_u32 v229, 512, v229
    v_add_u32 v225, 1024, v225
    s_add_u32 s14, s14, 1310720
    s_add_u32 s101, s101, 2
L_nt6_1:
    v_mfma_f32_16x16x32_bf16 v[116:119], v[0:3], v[172:175], v[116:119]
    v_cvt_pk_bf16_f32 v139, v242, v243
    v_mfma_f32_16x16x32_bf16 v[120:123], v[32:35], v[172:175], 0
    ds_read_b128 v[172:175], v220 offset:3008
    v_mfma_f32_16x16x32_bf16 v[116:119], v[4:7], v[176:179], v[116:119]
    v_mfma_f32_16x16x32_bf16 v[120:123], v[36:39], v[176:179], v[120:123]
    ds_read_b128 v[176:179], v220 offset:2992
    v_mfma_f32_16x16x32_bf16 v[116:119], v[8:11], v[180:183], v[116:119]
    v_mfma_f32_16x16x32_bf16 v[120:123], v[40:43], v[180:183], v[120:123]
    ds_read_b128 v[180:183], v220 offset:1984
    v_mfma_f32_16x16x32_bf16 v[116:119], v[12:15], v[184:187], v[116:119]
    ds_read_b32 v254, v229
    v_mfma_f32_16x16x32_bf16 v[120:123], v[44:47], v[184:187], v[120:123]
    ds_read_b128 v[184:187], v220 offset:4032
    v_mfma_f32_16x16x32_bf16 v[116:119], v[16:19], v[188:191], v[116:119]
    v_mfma_f32_16x16x32_bf16 v[120:123], v[48:51], v[188:191], v[120:123]
    ds_read_b128 v[188:191], v220 offset:3968
    s_waitcnt lgkmcnt(10)
    v_mfma_f32_16x16x32_bf16 v[116:119], v[20:23], v[192:195], v[116:119]
    v_mfma_f32_16x16x32_bf16 v[120:123], v[52:55], v[192:195], v[120:123]
    ds_read_b128 v[192:195], v220 offset:3904
    s_waitcnt lgkmcnt(3)
    v_readfirstlane_b32 s13, v254
    s_nop 0
    s_cmp_lt_u32 s13, 8
    s_cbranch_scc1 L_ns6_18
    ds_read_b64_tr_b16 v[232:233], v225
    ds_read_b64_tr_b16 v[234:235], v225 offset:45312
L_ns6_18:
    v_mfma_f32_16x16x32_bf16 v[116:119], v[24:27], v[164:167], v[116:119]
    v_mfma_f32_16x16x32_bf16 v[120:123], v[56:59], v[164:167], v[120:123]
    ds_read_b128 v[164:167], v220 offset:3840
    v_mfma_f32_16x16x32_bf16 v[116:119], v[28:31], v[168:171], v[116:119]
    v_mfma_f32_16x16x32_bf16 v[116:119], v[132:135], v[68:71], v[116:119]
    v_mfma_f32_16x16x32_bf16 v[116:119], v[136:139], v[72:75], v[116:119]
    s_cmp_lt_u32 s13, 8
    s_cbranch_scc1 L_nt6_18
    s_waitcnt lgkmcnt(1)
    buffer_store_dwordx4 v[232:235], v226, s[44:47], s14 offen
    v_add_u32 v229, 512, v229
    v_add_u32 v225, 1024, v225
    s_add_u32 s14, s14, 1310720
    s_add_u32 s101, s101, 2
L_nt6_18:
    v_mfma_f32_16x16x32_bf16 v[116:119], v[156:159], v[92:95], v[116:119]
    v_mfma_f32_16x16x32_bf16 v[120:123], v[60:63], v[168:171], v[120:123]
    ds_read_b128 v[168:171], v220 offset:3776
    s_setprio 0
    v_mfma_f32_16x16x32_bf16 v[140:143], v[172:175], v[200:203], 0
    v_mfma_f32_16x16x32_bf16 v[196:199], v[172:175], v[204:207], 0
    v_mfma_f32_16x16x32_bf16 v[120:123], v[64:67], v[172:175], v[120:123]
    ds_read_b128 v[172:175], v220 offset:3712
    v_mfma_f32_16x16x32_bf16 v[144:147], v[176:179], v[200:203], 0
    v_cvt_pk_bf16_f32 v248, v116, v117
    v_cvt_pk_bf16_f32 v249, v118, v119
    v_mfma_f32_16x16x32_bf16 v[240:243], v[176:179], v[204:207], 0
    ds_read_b128 v[176:179], v220 offset:3648
    v_mfma_f32_16x16x32_bf16 v[120:123], v[216:219], v[180:183], v[120:123]
    ds_read_b128 v[180:183], v220 offset:3584
    v_mfma_f32_16x16x32_bf16 v[120:123], v[124:127], v[84:87], v[120:123]
    ds_write_b64 v224, v[248:249] offset:3072
    v_mfma_f32_16x16x32_bf16 v[120:123], v[128:131], v[88:91], v[120:123]
    ds_add_u32 v252, v253 offset:1536
    v_mfma_f32_16x16x32_bf16 v[120:123], v[132:135], v[76:79], v[120:123]
    v_cvt_pk_bf16_f32 v140, v140, v141
    v_cvt_pk_bf16_f32 v141, v142, v143
    v_mfma_f32_16x16x32_bf16 v[120:123], v[136:139], v[80:83], v[120:123]
    v_cvt_pk_bf16_f32 v142, v196, v197
    v_cvt_pk_bf16_f32 v143, v198, v199
    v_mfma_f32_16x16x32_bf16 v[120:123], v[148:151], v[104:107], v[120:123]
    v_cvt_pk_bf16_f32 v144, v144, v145
    v_cvt_pk_bf16_f32 v145, v146, v147
    v_mfma_f32_16x16x32_bf16 v[120:123], v[152:155], v[100:103], v[120:123]
    v_cvt_pk_bf16_f32 v146, v240, v241
    v_cvt_pk_bf16_f32 v147, v242, v243
    v_mfma_f32_16x16x32_bf16 v[120:123], v[156:159], v[96:99], v[120:123]
    ds_read_b32 v254, v229
    s_waitcnt lgkmcnt(10)
    v_mfma_f32_16x16x32_bf16 v[120:123], v[0:3], v[184:187], v[120:123]
    s_waitcnt lgkmcnt(9)
    v_mfma_f32_16x16x32_bf16 v[120:123], v[4:7], v[188:191], v[120:123]
    s_waitcnt lgkmcnt(8)
    v_mfma_f32_16x16x32_bf16 v[120:123], v[8:11], v[192:195], v[120:123]
    s_waitcnt lgkmcnt(7)
    v_mfma_f32_16x16x32_bf16 v[120:123], v[12:15], v[164:167], v[120:123]
    s_waitcnt lgkmcnt(6)
    v_mfma_f32_16x16x32_bf16 v[120:123], v[16:19], v[168:171], v[120:123]
    s_waitcnt lgkmcnt(0)
    v_readfirstlane_b32 s13, v254
    s_nop 0
    s_cmp_lt_u32 s13, 8
    s_cbranch_scc1 L_ns7_12
    ds_read_b64_tr_b16 v[232:233], v225
    ds_read_b64_tr_b16 v[234:235], v225 offset:45312
L_ns7_12:
    v_mfma_f32_16x16x32_bf16 v[120:123], v[20:23], v[172:175], v[120:123]
    v_mfma_f32_16x16x32_bf16 v[120:123], v[24:27], v[176:179], v[120:123]
    v_mfma_f32_16x16x32_bf16 v[120:123], v[28:31], v[180:183], v[120:123]
    v_mfma_f32_16x16x32_bf16 v[120:123], v[140:143], v[68:71], v[120:123]
    v_mfma_f32_16x16x32_bf16 v[120:123], v[144:147], v[72:75], v[120:123]
    s_cmp_lt_u32 s13, 8
    s_cbranch_scc1 L_nt7_12
    s_waitcnt lgkmcnt(0)
    buffer_store_dwordx4 v[232:235], v226, s[44:47], s14 offen
    v_add_u32 v229, 512, v229
    v_add_u32 v225, 1024, v225
    s_add_u32 s14, s14, 1310720
    s_add_u32 s101, s101, 2
L_nt7_12:
    v_mfma_f32_16x16x32_bf16 v[120:123], v[160:163], v[92:95], v[120:123]
    s_nop 7
    v_cvt_pk_bf16_f32 v250, v120, v121
    v_cvt_pk_bf16_f32 v251, v122, v123
    ds_write_b64 v224, v[250:251] offset:3584
    ds_add_u32 v252, v253 offset:1792
L_svl:
    s_cmp_ge_u32 s101, 8
    s_cbranch_scc1 L_fin
L_svp:
    ds_read_b32 v254, v229
    ds_read_b64_tr_b16 v[232:233], v225
    ds_read_b64_tr_b16 v[234:235], v225 offset:45312
    s_sub_u32 s100, s100, 1
    s_cbranch_scc1 L_end
    s_waitcnt lgkmcnt(0)
    v_readfirstlane_b32 s13, v254
    s_nop 0
    s_cmp_ge_u32 s13, 8
    s_cbranch_scc1 L_svg
    s_sleep 1
    s_branch L_svp
L_svg:
    buffer_store_dwordx4 v[232:235], v226, s[44:47], s14 offen
    v_add_u32 v229, 512, v229
    v_add_u32 v225, 1024, v225
    s_add_u32 s14, s14, 1310720
    s_add_u32 s101, s101, 2
    s_branch L_svl
L_fin:
L_end:
    s_endpgm
L_hfin:
    s_waitcnt lgkmcnt(0)
    v_lshl_add_u32 v188, v1, 4, s9
    v_pk_mul_f16 v246, v116, v120 op_sel:[0,0] op_sel_hi:[1,0]
    v_mfma_f32_16x16x32_f16 v[56:59], v[108:111], v[104:107], v[56:59]
    ds_write_b128 v188, v[200:203] offset:0
    v_pk_mul_f16 v247, v117, v121 op_sel:[0,0] op_sel_hi:[1,0]
    v_pk_fma_f16 v120, v116, v120, v246 op_sel:[1,1,0] op_sel_hi:[0,1,1] neg_lo:[1,0,0]
    v_mfma_f32_16x16x32_f16 v[64:67], v[112:115], v[104:107], v[64:67]
    ds_write_b128 v188, v[204:207] offset:1024
    v_pk_fma_f16 v121, v117, v121, v247 op_sel:[1,1,0] op_sel_hi:[0,1,1] neg_lo:[1,0,0]
    v_pk_mul_f16 v246, v118, v122 op_sel:[0,0] op_sel_hi:[1,0]
    v_mfma_f32_16x16x32_f16 v[52:55], v[124:127], v[116:119], v[52:55]
    ds_write_b128 v188, v[208:211] offset:2048
    v_pk_mul_f16 v247, v119, v123 op_sel:[0,0] op_sel_hi:[1,0]
    v_pk_fma_f16 v122, v118, v122, v246 op_sel:[1,1,0] op_sel_hi:[0,1,1] neg_lo:[1,0,0]
    v_mfma_f32_16x16x32_f16 v[60:63], v[128:131], v[116:119], v[60:63]
    ds_write_b128 v188, v[212:215] offset:3072
    v_pk_fma_f16 v123, v119, v123, v247 op_sel:[1,1,0] op_sel_hi:[0,1,1] neg_lo:[1,0,0]
    s_nop 1
    v_mfma_f32_16x16x32_f16 v[56:59], v[124:127], v[120:123], v[56:59]
    v_mfma_f32_16x16x32_f16 v[64:67], v[128:131], v[120:123], v[64:67]
    v_mul_f32 v52, v32, v52
    v_mul_f32 v53, v32, v53
    v_mul_f32 v54, v32, v54
    v_mul_f32 v55, v32, v55
    v_mul_f32 v60, v32, v60
    v_mul_f32 v61, v33, v61
    v_mul_f32 v62, v33, v62
    v_mul_f32 v56, v32, v56
    v_mul_f32 v57, v32, v57
    v_mul_f32 v58, v32, v58
    v_mul_f32 v59, v32, v59
    v_mul_f32 v64, v32, v64
    v_mul_f32 v65, v33, v65
    v_mul_f32 v66, v33, v66
    ds_write_b128 v188, v[52:55] offset:4096
    ds_write_b128 v188, v[56:59] offset:5120
    ds_write_b128 v188, v[60:63] offset:6144
    ds_write_b128 v188, v[64:67] offset:7168
    ds_add_u32 v252, v253 offset:2560
    s_setprio 0
    s_cmp_lg_u32 s7, 0
    s_cbranch_scc1 L_fin
L_hown:
    s_cmp_lg_u32 s8, 5
    s_cbranch_scc1 L_nfl
    global_load_dword v219, v218, s[36:37] sc1
L_nfl:
    v_subrev_u32 v233, 1536, v233
    s_cmp_lg_u32 s8, 7
    s_cbranch_scc1 L_h56
    v_subrev_u32 v189, 983040, v234
    buffer_load_dwordx4 v[4:7], v189, s[40:43], 0 offen offset:0
    buffer_load_dwordx4 v[8:11], v189, s[40:43], 0 offen offset:1280
    buffer_load_dwordx4 v[12:15], v189, s[40:43], 0 offen offset:2560
    buffer_load_dwordx4 v[16:19], v189, s[40:43], 0 offen offset:3840
    buffer_load_dwordx4 v[36:39], v234, s[40:43], 0 offen offset:0
    buffer_load_dwordx4 v[40:43], v234, s[40:43], 0 offen offset:1280
    buffer_load_dwordx4 v[44:47], v234, s[40:43], 0 offen offset:2560
    buffer_load_dwordx4 v[48:51], v234, s[40:43], 0 offen offset:3840
    v_mov_b32 v189, 16
    s_waitcnt vmcnt(4)
    v_perm_b32 v172, v8, v4, s57
    v_perm_b32 v173, v16, v12, s57
    v_perm_b32 v174, v8, v4, s58
    v_perm_b32 v175, v16, v12, s58
    v_perm_b32 v176, v9, v5, s57
    v_perm_b32 v177, v17, v13, s57
    v_perm_b32 v178, v9, v5, s58
    v_perm_b32 v179, v17, v13, s58
    v_perm_b32 v180, v10, v6, s57
    v_perm_b32 v181, v18, v14, s57
    v_perm_b32 v182, v10, v6, s58
    v_perm_b32 v183, v18, v14, s58
    v_perm_b32 v184, v11, v7, s57
    v_perm_b32 v185, v19, v15, s57
    v_perm_b32 v186, v11, v7, s58
    v_perm_b32 v187, v19, v15, s58
    ds_write_b64 v233, v[172:173] offset:0
    ds_write_b64 v233, v[174:175] offset:4576
    ds_write_b64 v233, v[176:177] offset:9152
    ds_write_b64 v233, v[178:179] offset:13728
    ds_write_b64 v233, v[180:181] offset:18304
    ds_write_b64 v233, v[182:183] offset:22880
    ds_write_b64 v233, v[184:185] offset:27456
    ds_write_b64 v233, v[186:187] offset:32032
    ds_add_u32 v252, v189 offset:2304
    s_branch L_h7
L_h56:
    buffer_load_dwordx4 v[36:39], v234, s[40:43], 0 offen offset:0
    buffer_load_dwordx4 v[40:43], v234, s[40:43], 0 offen offset:1280
    buffer_load_dwordx4 v[44:47], v234, s[40:43], 0 offen offset:2560
    buffer_load_dwordx4 v[48:51], v234, s[40:43], 0 offen offset:3840
L_h7:
L_bw:
    ds_read_b32 v254, v252 offset:2048
    ds_read_b32 v255, v252 offset:2560
    s_sub_u32 s100, s100, 1
    s_cbranch_scc1 L_end
    s_waitcnt lgkmcnt(0)
    v_add_u32 v254, v254, v255
    s_sleep 1
    v_readfirstlane_b32 s12, v254
    s_nop 0
    s_cmp_lt_u32 s12, 7
    s_cbranch_scc1 L_bw
    s_setprio 2
    ds_read_b128 v[164:167], v220 offset:448
    ds_read_b128 v[168:171], v220 offset:432
    ds_read_b128 v[172:175], v220 offset:960
    ds_read_b128 v[176:179], v220 offset:944
    ds_read_b128 v[180:183], v220 offset:1472
    ds_read_b128 v[184:187], v220 offset:1456
    ds_read_b128 v[188:191], v220 offset:1984
    ds_read_b128 v[192:195], v220 offset:1968
    s_cmp_eq_u32 s8, 7
    s_cbranch_scc1 L_clrE
    ds_read_b128 v[200:203], v26 offset:0
    ds_read_b128 v[204:207], v26 offset:1024
    ds_read_b128 v[208:211], v26 offset:2048
    ds_read_b128 v[212:215], v26 offset:3072
    ds_add_u32 v252, v253 offset:2816
    s_cmp_lg_u32 s8, 5
    s_cbranch_scc1 L_clrE
    v_mov_b32 v217, 16
    s_waitcnt vmcnt(4)
L_clr:
    v_readfirstlane_b32 s12, v219
    s_nop 0
    s_and_b32 s12, s12, s67
    s_cmp_eq_u32 s12, s67
    s_cbranch_scc1 L_clrD
    s_sub_u32 s100, s100, 1
    s_cbranch_scc1 L_end
    s_sleep 8
    global_load_dword v219, v218, s[36:37] sc1
    s_waitcnt vmcnt(0)
    s_branch L_clr
L_clrD:
    ds_add_u32 v252, v217 offset:2816
L_clrE:
    s_waitcnt lgkmcnt(0)
    v_mfma_f32_16x16x32_bf16 v[124:127], v[164:167], v[200:203], 0
    v_mfma_f32_16x16x32_bf16 v[108:111], v[164:167], v[204:207], 0
    v_mfma_f32_16x16x32_bf16 v[128:131], v[168:171], v[200:203], 0
    v_mfma_f32_16x16x32_bf16 v[112:115], v[168:171], v[204:207], 0
    v_mfma_f32_16x16x32_bf16 v[148:151], v[164:167], v[208:211], 0
    v_mfma_f32_16x16x32_bf16 v[116:119], v[168:171], v[212:215], 0
    v_mfma_f32_16x16x32_bf16 v[132:135], v[172:175], v[200:203], 0
    s_nop 1
    v_cvt_pk_bf16_f32 v124, v124, v125
    v_cvt_pk_bf16_f32 v125, v126, v127
    v_mfma_f32_16x16x32_bf16 v[120:123], v[172:175], v[204:207], 0
    v_cvt_pk_bf16_f32 v126, v108, v109
    v_cvt_pk_bf16_f32 v127, v110, v111
    v_mfma_f32_16x16x32_bf16 v[136:139], v[176:179], v[200:203], 0
    v_cvt_pk_bf16_f32 v128, v128, v129
    v_cvt_pk_bf16_f32 v129, v130, v131
    v_mfma_f32_16x16x32_bf16 v[196:199], v[176:179], v[204:207], 0
    v_cvt_pk_bf16_f32 v130, v112, v113
    v_cvt_pk_bf16_f32 v131, v114, v115
    v_mfma_f32_16x16x32_bf16 v[152:155], v[172:175], v[208:211], 0
    v_cvt_pk_bf16_f32 v148, v148, v149
    v_cvt_pk_bf16_f32 v149, v150, v151
    v_mfma_f32_16x16x32_bf16 v[244:247], v[176:179], v[212:215], 0
    v_cvt_pk_bf16_f32 v150, v116, v117
    v_cvt_pk_bf16_f32 v151, v118, v119
    v_mfma_f32_16x16x32_bf16 v[140:143], v[180:183], v[200:203], 0
    v_cvt_pk_bf16_f32 v132, v132, v133
    v_cvt_pk_bf16_f32 v133, v134, v135
    v_mfma_f32_16x16x32_bf16 v[108:111], v[180:183], v[204:207], 0
    v_cvt_pk_bf16_f32 v134, v120, v121
    v_cvt_pk_bf16_f32 v135, v122, v123
    v_mfma_f32_16x16x32_bf16 v[144:147], v[184:187], v[200:203], 0
    v_cvt_pk_bf16_f32 v136, v136, v137
    v_cvt_pk_bf16_f32 v137, v138, v139
    v_mfma_f32_16x16x32_bf16 v[112:115], v[184:187], v[204:207], 0
    v_cvt_pk_bf16_f32 v138, v196, v197
    v_cvt_pk_bf16_f32 v139, v198, v199
    v_mfma_f32_16x16x32_bf16 v[156:159], v[180:183], v[208:211], 0
    v_cvt_pk_bf16_f32 v152, v152, v153
    v_cvt_pk_bf16_f32 v153, v154, v155
    v_mfma_f32_16x16x32_bf16 v[116:119], v[184:187], v[212:215], 0
    v_cvt_pk_bf16_f32 v154, v244, v245
    v_cvt_pk_bf16_f32 v155, v246, v247
    v_mfma_f32_16x16x32_bf16 v[160:163], v[188:191], v[208:211], 0
    v_cvt_pk_bf16_f32 v140, v140, v141
    v_cvt_pk_bf16_f32 v141, v142, v143
    v_mfma_f32_16x16x32_bf16 v[120:123], v[192:195], v[212:215], 0
    v_cvt_pk_bf16_f32 v142, v108, v109
    v_cvt_pk_bf16_f32 v143, v110, v111
    v_cvt_pk_bf16_f32 v144, v144, v145
    v_cvt_pk_bf16_f32 v145, v146, v147
    v_cvt_pk_bf16_f32 v146, v112, v113
    v_cvt_pk_bf16_f32 v147, v114, v115
    v_cvt_pk_bf16_f32 v156, v156, v157
    v_cvt_pk_bf16_f32 v157, v158, v159
    v_cvt_pk_bf16_f32 v158, v116, v117
    v_cvt_pk_bf16_f32 v159, v118, v119
    v_cvt_pk_bf16_f32 v160, v160, v161
    v_cvt_pk_bf16_f32 v161, v162, v163
    v_cvt_pk_bf16_f32 v162, v120, v121
    v_cvt_pk_bf16_f32 v163, v122, v123
L_cons:
    ds_read_b32 v254, v252 offset:2816
    s_sub_u32 s100, s100, 1
    s_cbranch_scc1 L_end
    s_waitcnt lgkmcnt(0)
    v_readfirstlane_b32 s12, v254
    s_nop 0
    s_cmp_lt_u32 s12, 23
    s_cbranch_scc1 L_cons
    global_load_dwordx4 v[84:87], v243, s[38:39] offset:0 sc1
    global_load_dwordx4 v[88:91], v243, s[38:39] offset:1024 sc1
    global_load_dwordx4 v[92:95], v243, s[38:39] offset:2048 sc1
    global_load_dwordx4 v[96:99], v243, s[38:39] offset:3072 sc1
    s_waitcnt vmcnt(4)
    v_perm_b32 v172, v40, v36, s57
    v_perm_b32 v173, v48, v44, s57
    v_perm_b32 v174, v40, v36, s58
    v_perm_b32 v175, v48, v44, s58
    v_perm_b32 v176, v41, v37, s57
    v_perm_b32 v177, v49, v45, s57
    v_perm_b32 v178, v41, v37, s58
    v_perm_b32 v179, v49, v45, s58
    v_perm_b32 v180, v42, v38, s57
    v_perm_b32 v181, v50, v46, s57
    v_perm_b32 v182, v42, v38, s58
    v_perm_b32 v183, v50, v46, s58
    v_perm_b32 v184, v43, v39, s57
    v_perm_b32 v185, v51, v47, s57
    v_perm_b32 v186, v43, v39, s58
    v_perm_b32 v187, v51, v47, s58
    ds_write_b64 v233, v[172:173] offset:1536
    ds_write_b64 v233, v[174:175] offset:6112
    ds_write_b64 v233, v[176:177] offset:10688
    ds_write_b64 v233, v[178:179] offset:15264
    ds_write_b64 v233, v[180:181] offset:19840
    ds_write_b64 v233, v[182:183] offset:24416
    ds_write_b64 v233, v[184:185] offset:28992
    ds_write_b64 v233, v[186:187] offset:33568
    ds_add_u32 v252, v253 offset:2304
    ds_read_b128 v[164:167], v220 offset:448
    ds_read_b128 v[168:171], v220 offset:384
    ds_read_b128 v[172:175], v220 offset:320
    ds_read_b128 v[176:179], v220 offset:256
    ds_read_b128 v[180:183], v220 offset:192
    ds_read_b128 v[184:187], v220 offset:128
    ds_read_b128 v[188:191], v220 offset:64
    ds_read_b128 v[192:195], v220 offset:0
    s_branch L_inb
L_inb0:
    s_sleep 2
    s_sub_u32 s100, s100, 1
    s_cbranch_scc1 L_end
    global_load_dwordx4 v[84:87], v243, s[38:39] offset:0 sc1
    global_load_dwordx4 v[88:91], v243, s[38:39] offset:1024 sc1
    global_load_dwordx4 v[92:95], v243, s[38:39] offset:2048 sc1
    global_load_dwordx4 v[96:99], v243, s[38:39] offset:3072 sc1
L_inb:
    s_waitcnt vmcnt(0)
    v_max3_u32 v100, v84, v85, v86
    v_max3_u32 v100, v87, v88, v100
    v_max3_u32 v100, v89, v90, v100
    v_max3_u32 v100, v91, v92, v100
    v_max3_u32 v100, v93, v94, v100
    v_max3_u32 v100, v95, v96, v100
    v_max3_u32 v100, v97, v98, v100
    v_max_u32 v100, v99, v100
    v_cmp_eq_u32 vcc, -1, v100
    s_nop 4
    s_cbranch_vccnz L_inb0
    ds_write_b64 v230, v[84:85] offset:256
    ds_write_b64 v230, v[86:87] offset:1472
    ds_write_b64 v230, v[88:89] offset:0
    ds_write_b64 v230, v[90:91] offset:1216
    s_mov_b64 exec, 1
    ds_write_b32 v227, v96 offset:2304
    s_mov_b64 exec, -1
    ds_read2_b32 v[0:1], v222 offset0:128 offset1:129
    ds_read2_b32 v[2:3], v222 offset0:130 offset1:131
    ds_read2_b32 v[32:33], v222 offset0:0 offset1:1
    ds_read2_b32 v[34:35], v222 offset0:2 offset1:3
    ds_read2_b32 v[4:5], v222 offset0:112 offset1:113
    ds_read2_b32 v[6:7], v222 offset0:114 offset1:115
    ds_read2_b32 v[36:37], v221 offset0:112 offset1:113
    ds_read2_b32 v[38:39], v221 offset0:114 offset1:115
    ds_read2_b32 v[8:9], v222 offset0:96 offset1:97
    ds_read2_b32 v[10:11], v222 offset0:98 offset1:99
    ds_read2_b32 v[40:41], v221 offset0:96 offset1:97
    ds_read2_b32 v[42:43], v221 offset0:98 offset1:99
    ds_read2_b32 v[12:13], v222 offset0:80 offset1:81
    ds_read2_b32 v[14:15], v222 offset0:82 offset1:83
    ds_read2_b32 v[44:45], v221 offset0:80 offset1:81
    ds_read2_b32 v[46:47], v221 offset0:82 offset1:83
    ds_read2_b32 v[16:17], v222 offset0:64 offset1:65
    ds_read2_b32 v[18:19], v222 offset0:66 offset1:67
    ds_read2_b32 v[48:49], v221 offset0:64 offset1:65
    ds_read2_b32 v[50:51], v221 offset0:66 offset1:67
    ds_read2_b32 v[20:21], v222 offset0:48 offset1:49
    ds_read2_b32 v[22:23], v222 offset0:50 offset1:51
    ds_read2_b32 v[52:53], v221 offset0:48 offset1:49
    ds_read2_b32 v[54:55], v221 offset0:50 offset1:51
    ds_read2_b32 v[24:25], v222 offset0:32 offset1:33
    ds_read2_b32 v[26:27], v222 offset0:34 offset1:35
    ds_read2_b32 v[56:57], v221 offset0:32 offset1:33
    ds_read2_b32 v[58:59], v221 offset0:34 offset1:35
    ds_read2_b32 v[28:29], v222 offset0:16 offset1:17
    ds_read2_b32 v[30:31], v222 offset0:18 offset1:19
    ds_read2_b32 v[60:61], v221 offset0:16 offset1:17
    ds_read2_b32 v[62:63], v221 offset0:18 offset1:19
    s_waitcnt lgkmcnt(0)
    s_branch L_conv
L_last:
    s_endpgm
.section .rodata,"a"
.p2align 6
.amdhsa_kernel concat_heads__ssm_conv_s4d__ssm_conv_s4__prompt_kernel
  .amdhsa_next_free_vgpr 256
  .amdhsa_next_free_sgpr 102
  .amdhsa_accum_offset 256
  .amdhsa_group_segment_fixed_size 0
  .amdhsa_kernarg_size 152
  .amdhsa_user_sgpr_count 2
  .amdhsa_user_sgpr_kernarg_segment_ptr 1
  .amdhsa_system_sgpr_workgroup_id_x 1
  .amdhsa_ieee_mode 0
.end_amdhsa_kernel
```
